```python
import torch

def _softmax(x, axis=-1):
    return torch.softmax(x, dim=axis)
def _gelu(x):
    return torch.nn.functional.gelu(x, approximate="tanh")
def _silu(x):
    return torch.nn.functional.silu(x)
def _sigmoid(x):
    return torch.sigmoid(x)
def _layernorm(x, axis=-1, eps=1e-5):
    m = x.mean(dim=axis, keepdim=True)
    v = x.var(dim=axis, keepdim=True, unbiased=False)
    return (x - m) / torch.sqrt(v + eps)
def _scatter_add(tgt, idx, src, axis=0):
    return tgt.clone().index_add_(axis, idx, src)
def _segment_sum(src, seg, n):
    out = torch.zeros((n,) + src.shape[1:], dtype=src.dtype)
    return out.index_add_(0, seg, src)
def _pad(x, pw):
    flat = tuple(v for pair in reversed(pw) for v in pair)
    return torch.nn.functional.pad(x, flat)

kernel_name = 'concat_heads__mha_block_cached__gqa_block_cached__near_ridge'

def setup_inputs():

    _w = (lambda a: (lambda t: t.to(torch.bfloat16) if t.is_floating_point() else t)(torch.as_tensor(a)))
    def _A_setup():
        B, Sq, D = 16, 144, 576
        H, Sk, Dh = 32, 512, 128
        return {
            "x": _w((lambda *s: torch.randn(*s, dtype=torch.bfloat16) * 0.8)(B, Sq, D)),
            "k_cache": _w((lambda *s: torch.randn(*s, dtype=torch.bfloat16) * 0.8)(B, H, Sk, Dh)),
            "v_cache": _w((lambda *s: torch.randn(*s, dtype=torch.bfloat16) * 0.05)(B, H, Sk, Dh)),
            "wq": _w((lambda *s: torch.randn(*s, dtype=torch.bfloat16) * 0.8)(D, H * Dh) * (D ** -0.5)),
            "wo": _w((lambda *s: torch.randn(*s, dtype=torch.bfloat16) * 0.05)(H * Dh, D) * ((H * Dh) ** -0.5)),
        }
    _A_in = _A_setup()

    def _B_setup():
        B, Sq, D = 16, 144, 576
        Hq, Hkv, Sk, Dh = 32, 32, 512, 128
        assert Hq % Hkv == 0, (Hq, Hkv)
        return {
            "x": _w((lambda *s: torch.randn(*s, dtype=torch.bfloat16) * 0.8)(B, Sq, D)),
            "k_cache": _w((lambda *s: torch.randn(*s, dtype=torch.bfloat16) * 0.8)(B, Hkv, Sk, Dh)),
            "v_cache": _w((lambda *s: torch.randn(*s, dtype=torch.bfloat16) * 0.05)(B, Hkv, Sk, Dh)),
            "wq": _w((lambda *s: torch.randn(*s, dtype=torch.bfloat16) * 0.8)(D, Hq * Dh) * (D ** -0.5)),
            "wo": _w((lambda *s: torch.randn(*s, dtype=torch.bfloat16) * 0.05)(Hq * Dh, D) * ((Hq * Dh) ** -0.5)),
        }
    _B_in = _B_setup()

    return {
        "A_x": _A_in["x"],
        "A_k_cache": _A_in["k_cache"],
        "A_v_cache": _A_in["v_cache"],
        "A_wq": _A_in["wq"],
        "A_wo": _A_in["wo"],
        "B_x": _B_in["x"],
        "B_k_cache": _B_in["k_cache"],
        "B_v_cache": _B_in["v_cache"],
        "B_wq": _B_in["wq"],
        "B_wo": _B_in["wo"],
    }

def reference(A_x, A_k_cache, A_v_cache, A_wq, A_wo, B_x, B_k_cache, B_v_cache, B_wq, B_wo):
    def _A_ref(x, k_cache, v_cache, wq, wo):
        B, Sq, D = x.shape
        H, Dh = 32, 128
        q = (lambda x, *d: x.permute(*d))((x @ wq).reshape(B, Sq, H, Dh), 0, 2, 1, 3)
        scores = torch.einsum("bhqd,bhkd->bhqk", q, k_cache) * (Dh ** -0.5)
        p = _softmax(scores, axis=-1)
        o = torch.einsum("bhqk,bhkd->bhqd", p, v_cache)
        return (lambda x, *d: x.permute(*d))(o, 0, 2, 1, 3).reshape(B, Sq, H * Dh) @ wo

    def _B_ref(x, k_cache, v_cache, wq, wo):
        B, Sq, D = x.shape
        Hq, Dh = 32, 128
        Hkv = k_cache.shape[1]
        rep = Hq // Hkv
        q = (lambda x, *d: x.permute(*d))((x @ wq).reshape(B, Sq, Hq, Dh), 0, 2, 1, 3)
        k = (lambda x, n, axis: torch.repeat_interleave(x, n, dim=axis))(k_cache, rep, axis=1)
        v = (lambda x, n, axis: torch.repeat_interleave(x, n, dim=axis))(v_cache, rep, axis=1)
        scores = torch.einsum("bhqd,bhkd->bhqk", q, k) * (Dh ** -0.5)
        p = _softmax(scores, axis=-1)
        o = torch.einsum("bhqk,bhkd->bhqd", p, v)
        return (lambda x, *d: x.permute(*d))(o, 0, 2, 1, 3).reshape(B, Sq, Hq * Dh) @ wo

    a = _A_ref(A_x, A_k_cache, A_v_cache, A_wq, A_wo)
    b = _B_ref(B_x, B_k_cache, B_v_cache, B_wq, B_wo)
    return torch.concatenate([a, b], axis=-1)
```

```asm
; @launch grid=(256,1,1) block=(512,1,1) lds=163072
.amdgcn_target "amdgcn-amd-amdhsa--gfx950"
.text
.globl concat_heads__mha_block_cached__gqa_block_cached__near_ridge_kernel
.p2align 8
.type concat_heads__mha_block_cached__gqa_block_cached__near_ridge_kernel,@function
concat_heads__mha_block_cached__gqa_block_cached__near_ridge_kernel:
    s_cmp_ge_u32 s2, 256
    s_cbranch_scc1 L_end
    s_load_dwordx16 s[4:19], s[0:1], 0
    s_load_dwordx8 s[20:27], s[0:1], 64
    s_load_dwordx2 s[28:29], s[0:1], 96
    v_lshrrev_b32 v1, 6, v0
    s_nop 0
    v_readfirstlane_b32 s64, v1
    v_and_b32 v0, 63, v0
    v_lshlrev_b32 v1, 2, v0
    v_add_u32 v1, 161792, v1
    v_mov_b32 v2, 0
    ds_write_b32 v1, v2 offset:0
    ds_write_b32 v1, v2 offset:256
    ds_write_b32 v1, v2 offset:512
    ds_write_b32 v1, v2 offset:768
    ds_write_b32 v1, v2 offset:1024
    s_and_b32 s65, s64, 3
    s_and_b32 s3, s2, 7
    s_lshl_b32 s3, s3, 2
    s_lshr_b32 s66, s2, 6
    s_add_u32 s66, s66, s3
    s_lshr_b32 s68, s2, 3
    s_and_b32 s68, s68, 7
    s_and_b32 s67, s66, 15
    s_lshr_b32 s69, s66, 4
    s_mov_b32 s90, 0x40000
    s_mov_b32 s34, 2654208
    s_mov_b32 s35, 0x20000
    s_mov_b32 s38, 67108864
    s_mov_b32 s39, 0x20000
    s_mov_b32 s42, 67108864
    s_mov_b32 s43, 0x20000
    s_mov_b32 s46, 4718592
    s_mov_b32 s47, 0x20000
    s_mov_b32 s50, 4718592
    s_mov_b32 s51, 0x20000
    s_mov_b32 s54, 5308416
    s_mov_b32 s55, 0x20000
    s_mov_b32 s58, 256
    s_mov_b32 s59, 0x20000
    s_mov_b32 s62, 292618240
    s_mov_b32 s63, 0x20000
    s_waitcnt lgkmcnt(0)
    s_cmp_eq_u32 s69, 0
    s_cselect_b32 s32, s4, s14
    s_cselect_b32 s33, s5, s15
    s_cselect_b32 s36, s6, s16
    s_cselect_b32 s37, s7, s17
    s_cselect_b32 s40, s8, s18
    s_cselect_b32 s41, s9, s19
    s_cselect_b32 s44, s10, s20
    s_cselect_b32 s45, s11, s21
    s_cselect_b32 s48, s12, s22
    s_cselect_b32 s49, s13, s23
    s_mov_b32 s52, s24
    s_and_b32 s53, s25, 0xffff
    s_mov_b32 s56, s26
    s_and_b32 s57, s27, 0xffff
    s_mov_b32 s60, s28
    s_and_b32 s61, s29, 0xffff
    s_and_b32 s33, s33, 0xffff
    s_and_b32 s37, s37, 0xffff
    s_and_b32 s41, s41, 0xffff
    s_and_b32 s45, s45, 0xffff
    s_and_b32 s49, s49, 0xffff
    s_barrier
    s_cmp_lt_u32 s64, 4
    s_nop 1
    s_cbranch_scc1 L_A
    v_lshrrev_b32 v2, 4, v0
    v_and_b32 v1, 7, v0
    v_lshrrev_b32 v3, 3, v0
    v_lshlrev_b32 v7, 1, v2
    v_xor_b32 v7, v7, v1
    v_mul_u32_u24 v8, 1152, v3
    v_lshl_add_u32 v8, v7, 4, v8
    v_and_b32 v7, 1, v2
    v_lshlrev_b32 v7, 1, v7
    v_xor_b32 v7, v7, v1
    v_lshlrev_b32 v9, 13, v3
    v_lshl_add_u32 v9, v7, 4, v9
    v_xor_b32 v10, 64, v9
    s_mul_i32 s78, s67, 165888
    s_mul_i32 s71, s65, 36864
    s_add_u32 s71, s71, s78
    s_lshr_b32 s75, s65, 1
    s_mul_i32 s75, s75, 9216
    s_add_u32 s78, s78, s75
    s_add_u32 s78, s78, 147456
    s_lshl_b32 s94, s68, 10
    s_lshl_b32 s75, s65, 7
    s_add_u32 s94, s94, s75
    s_and_b32 s96, s66, 3
    s_lshl_b32 s96, s96, 1
    s_add_u32 s96, s96, s68
    s_and_b32 s75, s65, 1
    s_cmp_eq_u32 s75, 0
    s_cselect_b32 s86, -1, 0
    s_cselect_b32 s87, 0, -1
    s_mov_b32 s73, 0
    s_mov_b32 s70, 0
L_G_task:
    s_lshl_b32 s84, s65, 13
    s_add_u32 s84, s84, 129024
    s_lshl_b32 s83, s65, 12
    s_mov_b32 s79, 73728
    s_mov_b32 s80, 73728
    s_sub_u32 s75, s96, 9
    s_cselect_b32 s75, s96, s75
    s_lshl_b32 s81, s75, 7
    s_lshl_b32 s72, s75, 19
    s_add_u32 s72, s72, s94
    s_add_u32 s95, s94, 4718592
    s_mov_b32 s92, 8
    s_mov_b32 s93, 17
    s_lshr_b32 s76, s65, 1
    s_lshl_b32 s76, s76, 10
    s_add_u32 s76, s76, 16384
    s_add_u32 m0, s84, 0
    s_nop 0
    buffer_load_dwordx4 v9, s[44:47], s72 offen lds
    s_add_u32 s72, s72, 65536
    s_add_u32 m0, s84, 1024
    s_nop 0
    buffer_load_dwordx4 v10, s[44:47], s72 offen lds
    s_add_u32 s72, s72, 65536
    s_add_u32 m0, s84, 2048
    s_nop 0
    buffer_load_dwordx4 v9, s[44:47], s72 offen lds
    s_add_u32 s72, s72, 65536
    s_add_u32 m0, s84, 3072
    s_nop 0
    buffer_load_dwordx4 v10, s[44:47], s72 offen lds
    s_add_u32 s72, s72, 65536
    s_cmp_eq_u32 s72, s95
    s_cselect_b32 s72, s94, s72
    s_sub_u32 s93, s93, 1
    s_cselect_b32 s72, 1073741824, s72
    s_cselect_b32 s84, 0x30000, s84
    s_add_u32 m0, s79, s83
    s_add_u32 s75, s71, s81
    buffer_load_dwordx4 v8, s[32:35], s75 offen lds
    s_add_u32 m0, m0, 1024
    s_add_u32 s75, s75, 9216
    buffer_load_dwordx4 v8, s[32:35], s75 offen lds
    s_add_u32 m0, m0, 1024
    s_add_u32 s75, s75, 9216
    buffer_load_dwordx4 v8, s[32:35], s75 offen lds
    s_add_u32 m0, m0, 1024
    s_add_u32 s75, s75, 9216
    buffer_load_dwordx4 v8, s[32:35], s75 offen lds
    s_add_u32 m0, s79, s76
    s_add_u32 s75, s78, s81
    s_mov_b64 exec, s[86:87]
    buffer_load_dwordx4 v8, s[32:35], s75 offen lds
    s_mov_b64 exec, -1
    s_add_u32 s81, s81, 128
    s_cmp_eq_u32 s81, 1152
    s_cselect_b32 s81, 0, s81
    s_sub_u32 s92, s92, 1
    s_cselect_b32 s81, 1073741824, s81
    s_cselect_b32 s83, 0x18000, s83
    s_cselect_b32 s76, 0x18000, s76
    s_add_u32 s79, s79, 18432
    s_cmp_eq_u32 s79, 129024
    s_cselect_b32 s79, 73728, s79
    v_and_b32 v1, 15, v0
    v_lshrrev_b32 v2, 4, v0
    v_lshlrev_b32 v17, 4, v1
    v_lshrrev_b32 v3, 1, v2
    v_lshl_add_u32 v17, v3, 8, v17
    v_and_b32 v3, 1, v2
    v_lshl_add_u32 v17, v3, 3, v17
    v_and_b32 v7, 6, v0
    v_xor_b32 v7, v7, v2
    v_lshlrev_b32 v18, 7, v1
    v_lshl_add_u32 v18, v7, 4, v18
    v_lshlrev_b32 v11, 10, v2
    v_bfe_u32 v1, v0, 2, 2
    v_lshl_add_u32 v11, v1, 7, v11
    v_bfe_u32 v1, v0, 3, 2
    v_lshl_add_u32 v11, v1, 5, v11
    v_and_b32 v1, 3, v0
    v_lshl_add_u32 v11, v1, 3, v11
    v_xor_b32 v12, 32, v11
    v_xor_b32 v13, 64, v11
    v_xor_b32 v14, 96, v11
    v_add_u32 v11, s84, v11
    v_add_u32 v12, s84, v12
    v_add_u32 v13, s84, v13
    v_add_u32 v14, s84, v14
    v_lshlrev_b32 v4, 2, v0
    v_add_u32 v4, 161792, v4
    v_mov_b32 v5, 0x7fffffff
    s_lshr_b32 s75, s65, 1
    s_mul_i32 s74, s75, 36864
    s_add_u32 s74, s74, 73728
    s_and_b32 s75, s65, 1
    s_lshl_b32 s75, s75, 11
    v_add_u32 v17, s75, v17
    s_mov_b32 s77, 0x3e0293ee
    v_add_u32 v15, s80, v18
    v_xor_b32 v16, 64, v15
    v_mov_b32 v88, 0
    v_mov_b32 v89, 0
    v_mov_b32 v90, 0
    v_mov_b32 v91, 0
    v_mov_b32 v92, 0
    v_mov_b32 v93, 0
    v_mov_b32 v94, 0
    v_mov_b32 v95, 0
    v_mov_b32 v96, 0
    v_mov_b32 v97, 0
    v_mov_b32 v98, 0
    v_mov_b32 v99, 0
    v_mov_b32 v100, 0
    v_mov_b32 v101, 0
    v_mov_b32 v102, 0
    v_mov_b32 v103, 0
    v_mov_b32 v104, 0
    v_mov_b32 v105, 0
    v_mov_b32 v106, 0
    v_mov_b32 v107, 0
    v_mov_b32 v108, 0
    v_mov_b32 v109, 0
    v_mov_b32 v110, 0
    v_mov_b32 v111, 0
    v_mov_b32 v112, 0
    v_mov_b32 v113, 0
    v_mov_b32 v114, 0
    v_mov_b32 v115, 0
    v_mov_b32 v116, 0
    v_mov_b32 v117, 0
    v_mov_b32 v118, 0
    v_mov_b32 v119, 0
    v_mov_b32 v120, 0
    v_mov_b32 v121, 0
    v_mov_b32 v122, 0
    v_mov_b32 v123, 0
    v_mov_b32 v124, 0
    v_mov_b32 v125, 0
    v_mov_b32 v126, 0
    v_mov_b32 v127, 0
    v_mov_b32 v128, 0
    v_mov_b32 v129, 0
    v_mov_b32 v130, 0
    v_mov_b32 v131, 0
    v_mov_b32 v132, 0
    v_mov_b32 v133, 0
    v_mov_b32 v134, 0
    v_mov_b32 v135, 0
    v_mov_b32 v136, 0
    v_mov_b32 v137, 0
    v_mov_b32 v138, 0
    v_mov_b32 v139, 0
    v_mov_b32 v140, 0
    v_mov_b32 v141, 0
    v_mov_b32 v142, 0
    v_mov_b32 v143, 0
    v_mov_b32 v144, 0
    v_mov_b32 v145, 0
    v_mov_b32 v146, 0
    v_mov_b32 v147, 0
    v_mov_b32 v148, 0
    v_mov_b32 v149, 0
    v_mov_b32 v150, 0
    v_mov_b32 v151, 0
    v_mov_b32 v152, 0
    v_mov_b32 v153, 0
    v_mov_b32 v154, 0
    v_mov_b32 v155, 0
    v_mov_b32 v156, 0
    v_mov_b32 v157, 0
    v_mov_b32 v158, 0
    v_mov_b32 v159, 0
    v_mov_b32 v160, 0
    v_mov_b32 v161, 0
    v_mov_b32 v162, 0
    v_mov_b32 v163, 0
    v_mov_b32 v164, 0
    v_mov_b32 v165, 0
    v_mov_b32 v166, 0
    v_mov_b32 v167, 0
    v_mov_b32 v168, 0
    v_mov_b32 v169, 0
    v_mov_b32 v170, 0
    v_mov_b32 v171, 0
    v_mov_b32 v172, 0
    v_mov_b32 v173, 0
    v_mov_b32 v174, 0
    v_mov_b32 v175, 0
    v_mov_b32 v176, 0
    v_mov_b32 v177, 0
    v_mov_b32 v178, 0
    v_mov_b32 v179, 0
    v_mov_b32 v180, 0
    v_mov_b32 v181, 0
    v_mov_b32 v182, 0
    v_mov_b32 v183, 0
    v_mov_b32 v184, 0
    v_mov_b32 v185, 0
    v_mov_b32 v186, 0
    v_mov_b32 v187, 0
    v_mov_b32 v188, 0
    v_mov_b32 v189, 0
    v_mov_b32 v190, 0
    v_mov_b32 v191, 0
    v_mov_b32 v192, 0
    v_mov_b32 v193, 0
    v_mov_b32 v194, 0
    v_mov_b32 v195, 0
    v_mov_b32 v196, 0
    v_mov_b32 v197, 0
    v_mov_b32 v198, 0
    v_mov_b32 v199, 0
    v_mov_b32 v200, 0
    v_mov_b32 v201, 0
    v_mov_b32 v202, 0
    v_mov_b32 v203, 0
    v_mov_b32 v204, 0
    v_mov_b32 v205, 0
    v_mov_b32 v206, 0
    v_mov_b32 v207, 0
    v_mov_b32 v208, 0
    v_mov_b32 v209, 0
    v_mov_b32 v210, 0
    v_mov_b32 v211, 0
    v_mov_b32 v212, 0
    v_mov_b32 v213, 0
    v_mov_b32 v214, 0
    v_mov_b32 v215, 0
    v_mov_b32 v216, 0
    v_mov_b32 v217, 0
    v_mov_b32 v218, 0
    v_mov_b32 v219, 0
    v_mov_b32 v220, 0
    v_mov_b32 v221, 0
    v_mov_b32 v222, 0
    v_mov_b32 v223, 0
    v_mov_b32 v224, 0
    v_mov_b32 v225, 0
    v_mov_b32 v226, 0
    v_mov_b32 v227, 0
    v_mov_b32 v228, 0
    v_mov_b32 v229, 0
    v_mov_b32 v230, 0
    v_mov_b32 v231, 0
    s_add_u32 m0, s79, s83
    s_add_u32 s75, s71, s81
    buffer_load_dwordx4 v8, s[32:35], s75 offen lds
    s_add_u32 m0, m0, 1024
    s_add_u32 s75, s75, 9216
    buffer_load_dwordx4 v8, s[32:35], s75 offen lds
    s_add_u32 m0, m0, 1024
    s_add_u32 s75, s75, 9216
    buffer_load_dwordx4 v8, s[32:35], s75 offen lds
    s_add_u32 m0, m0, 1024
    s_add_u32 s75, s75, 9216
    buffer_load_dwordx4 v8, s[32:35], s75 offen lds
    s_add_u32 m0, s79, s76
    s_add_u32 s75, s78, s81
    s_mov_b64 exec, s[86:87]
    buffer_load_dwordx4 v8, s[32:35], s75 offen lds
    s_mov_b64 exec, -1
    s_add_u32 s81, s81, 128
    s_cmp_eq_u32 s81, 1152
    s_cselect_b32 s81, 0, s81
    s_sub_u32 s92, s92, 1
    s_cselect_b32 s81, 1073741824, s81
    s_cselect_b32 s83, 0x18000, s83
    s_cselect_b32 s76, 0x18000, s76
    s_add_u32 s79, s79, 18432
    s_cmp_eq_u32 s79, 129024
    s_cselect_b32 s79, 73728, s79
    s_add_u32 m0, s84, 4096
    s_nop 0
    buffer_load_dwordx4 v9, s[44:47], s72 offen lds
    s_add_u32 s72, s72, 65536
    s_add_u32 m0, s84, 5120
    s_nop 0
    buffer_load_dwordx4 v10, s[44:47], s72 offen lds
    s_add_u32 s72, s72, 65536
    s_add_u32 m0, s84, 6144
    s_nop 0
    buffer_load_dwordx4 v9, s[44:47], s72 offen lds
    s_add_u32 s72, s72, 65536
    s_add_u32 m0, s84, 7168
    s_nop 0
    buffer_load_dwordx4 v10, s[44:47], s72 offen lds
    s_add_u32 s72, s72, 65536
    s_cmp_eq_u32 s72, s95
    s_cselect_b32 s72, s94, s72
    s_sub_u32 s93, s93, 1
    s_cselect_b32 s72, 1073741824, s72
    s_cselect_b32 s84, 0x30000, s84
    s_waitcnt vmcnt(9)
    s_add_u32 s70, s70, 4
    ds_inc_u32 v4, v5 offset:256
    ds_read_b64_tr_b16 v[56:57], v11 offset:0
    ds_read_b64_tr_b16 v[58:59], v11 offset:512
    ds_read_b64_tr_b16 v[60:61], v12 offset:0
    ds_read_b64_tr_b16 v[62:63], v12 offset:512
    ds_read_b64_tr_b16 v[64:65], v13 offset:0
    ds_read_b64_tr_b16 v[66:67], v13 offset:512
    ds_read_b64_tr_b16 v[68:69], v14 offset:0
    ds_read_b64_tr_b16 v[70:71], v14 offset:512
L_fw_1:
    s_sub_u32 s90, s90, 1
    s_cbranch_scc1 L_bail
    ds_read_b32 v7, v4 offset:256
    s_waitcnt lgkmcnt(0)
    v_cmp_gt_u32 vcc, s70, v7
    s_cbranch_vccnz L_fw_1
    ds_read_b128 v[20:23], v15 offset:0
    ds_read_b128 v[24:27], v15 offset:2048
    ds_read_b128 v[28:31], v15 offset:4096
    ds_read_b128 v[32:35], v15 offset:6144
    ds_read_b128 v[36:39], v15 offset:8192
    ds_read_b128 v[40:43], v15 offset:10240
    ds_read_b128 v[44:47], v15 offset:12288
    ds_read_b128 v[48:51], v15 offset:14336
    ds_read_b128 v[52:55], v15 offset:16384
    s_add_u32 m0, s84, 0
    s_nop 0
    buffer_load_dwordx4 v9, s[44:47], s72 offen lds
    s_add_u32 s72, s72, 65536
    s_add_u32 m0, s84, 1024
    s_nop 0
    buffer_load_dwordx4 v10, s[44:47], s72 offen lds
    s_add_u32 s72, s72, 65536
    s_add_u32 m0, s84, 2048
    s_nop 0
    buffer_load_dwordx4 v9, s[44:47], s72 offen lds
    s_add_u32 s72, s72, 65536
    s_add_u32 m0, s84, 3072
    s_nop 0
    buffer_load_dwordx4 v10, s[44:47], s72 offen lds
    s_add_u32 s72, s72, 65536
    s_cmp_eq_u32 s72, s95
    s_cselect_b32 s72, s94, s72
    s_sub_u32 s93, s93, 1
    s_cselect_b32 s72, 1073741824, s72
    s_cselect_b32 s84, 0x30000, s84
    s_add_u32 m0, s79, s83
    s_add_u32 s75, s71, s81
    buffer_load_dwordx4 v8, s[32:35], s75 offen lds
    s_add_u32 m0, m0, 1024
    s_add_u32 s75, s75, 9216
    buffer_load_dwordx4 v8, s[32:35], s75 offen lds
    s_add_u32 m0, m0, 1024
    s_add_u32 s75, s75, 9216
    buffer_load_dwordx4 v8, s[32:35], s75 offen lds
    s_add_u32 m0, m0, 1024
    s_add_u32 s75, s75, 9216
    buffer_load_dwordx4 v8, s[32:35], s75 offen lds
    s_add_u32 m0, s79, s76
    s_add_u32 s75, s78, s81
    s_mov_b64 exec, s[86:87]
    buffer_load_dwordx4 v8, s[32:35], s75 offen lds
    s_mov_b64 exec, -1
    s_add_u32 s81, s81, 128
    s_cmp_eq_u32 s81, 1152
    s_cselect_b32 s81, 0, s81
    s_sub_u32 s92, s92, 1
    s_cselect_b32 s81, 1073741824, s81
    s_cselect_b32 s83, 0x18000, s83
    s_cselect_b32 s76, 0x18000, s76
    s_add_u32 s79, s79, 18432
    s_cmp_eq_u32 s79, 129024
    s_cselect_b32 s79, 73728, s79
    s_waitcnt lgkmcnt(0)
    s_nop 1
    s_mov_b32 s82, 9
.p2align 6
L_G_loop:
    s_waitcnt lgkmcnt(8)
    v_mfma_f32_16x16x32_bf16 v[88:91], v[56:59], v[20:23], v[88:91]
    s_waitcnt vmcnt(9)
    ds_read_b64_tr_b16 v[72:73], v11 offset:4096
    v_mfma_f32_16x16x32_bf16 v[92:95], v[60:63], v[20:23], v[92:95]
    ds_read_b64_tr_b16 v[74:75], v11 offset:4608
    v_mfma_f32_16x16x32_bf16 v[96:99], v[64:67], v[20:23], v[96:99]
    ds_read_b64_tr_b16 v[76:77], v12 offset:4096
    v_mfma_f32_16x16x32_bf16 v[100:103], v[68:71], v[20:23], v[100:103]
    ds_read_b128 v[20:23], v16 offset:0
    s_waitcnt lgkmcnt(11)
    v_mfma_f32_16x16x32_bf16 v[104:107], v[56:59], v[24:27], v[104:107]
    ds_read_b64_tr_b16 v[78:79], v12 offset:4608
    v_mfma_f32_16x16x32_bf16 v[108:111], v[60:63], v[24:27], v[108:111]
    ds_read_b64_tr_b16 v[80:81], v13 offset:4096
    v_mfma_f32_16x16x32_bf16 v[112:115], v[64:67], v[24:27], v[112:115]
    ds_inc_u32 v4, v5 offset:256
    v_mfma_f32_16x16x32_bf16 v[116:119], v[68:71], v[24:27], v[116:119]
    ds_read_b128 v[24:27], v16 offset:2048
    s_add_u32 s70, s70, 4
    s_waitcnt lgkmcnt(14)
    v_mfma_f32_16x16x32_bf16 v[120:123], v[56:59], v[28:31], v[120:123]
    ds_read_b64_tr_b16 v[82:83], v13 offset:4608
    v_mfma_f32_16x16x32_bf16 v[124:127], v[60:63], v[28:31], v[124:127]
    ds_read_b64_tr_b16 v[84:85], v14 offset:4096
    v_mfma_f32_16x16x32_bf16 v[128:131], v[64:67], v[28:31], v[128:131]
    ds_read_b64_tr_b16 v[86:87], v14 offset:4608
    v_mfma_f32_16x16x32_bf16 v[132:135], v[68:71], v[28:31], v[132:135]
    ds_read_b128 v[28:31], v16 offset:4096
    s_waitcnt lgkmcnt(15)
    v_mfma_f32_16x16x32_bf16 v[136:139], v[56:59], v[32:35], v[136:139]
    v_mfma_f32_16x16x32_bf16 v[140:143], v[60:63], v[32:35], v[140:143]
    v_mfma_f32_16x16x32_bf16 v[144:147], v[64:67], v[32:35], v[144:147]
    s_waitcnt lgkmcnt(1)
    s_add_u32 m0, s84, 4096
    v_mfma_f32_16x16x32_bf16 v[148:151], v[68:71], v[32:35], v[148:151]
    ds_read_b128 v[32:35], v16 offset:6144
    v_mfma_f32_16x16x32_bf16 v[152:155], v[56:59], v[36:39], v[152:155]
    buffer_load_dwordx4 v9, s[44:47], s72 offen lds
    v_mfma_f32_16x16x32_bf16 v[156:159], v[60:63], v[36:39], v[156:159]
    s_add_u32 s72, s72, 65536
    s_add_u32 m0, s84, 5120
    v_mfma_f32_16x16x32_bf16 v[160:163], v[64:67], v[36:39], v[160:163]
    buffer_load_dwordx4 v10, s[44:47], s72 offen lds
    v_mfma_f32_16x16x32_bf16 v[164:167], v[68:71], v[36:39], v[164:167]
    ds_read_b128 v[36:39], v16 offset:8192
    s_add_u32 s72, s72, 65536
    v_mfma_f32_16x16x32_bf16 v[168:171], v[56:59], v[40:43], v[168:171]
    s_add_u32 m0, s84, 6144
    v_mfma_f32_16x16x32_bf16 v[172:175], v[60:63], v[40:43], v[172:175]
    buffer_load_dwordx4 v9, s[44:47], s72 offen lds
    v_mfma_f32_16x16x32_bf16 v[176:179], v[64:67], v[40:43], v[176:179]
    s_add_u32 s72, s72, 65536
    s_add_u32 m0, s84, 7168
    v_mfma_f32_16x16x32_bf16 v[180:183], v[68:71], v[40:43], v[180:183]
    ds_read_b128 v[40:43], v16 offset:10240
    v_mfma_f32_16x16x32_bf16 v[184:187], v[56:59], v[44:47], v[184:187]
    buffer_load_dwordx4 v10, s[44:47], s72 offen lds
    v_mfma_f32_16x16x32_bf16 v[188:191], v[60:63], v[44:47], v[188:191]
    ds_read_b32 v7, v4 offset:256
    s_add_u32 s72, s72, 65536
    v_mfma_f32_16x16x32_bf16 v[192:195], v[64:67], v[44:47], v[192:195]
    s_cmp_eq_u32 s72, s95
    s_cselect_b32 s72, s94, s72
    s_sub_u32 s93, s93, 1
    s_cselect_b32 s72, 1073741824, s72
    s_cselect_b32 s84, 0x30000, s84
    v_mfma_f32_16x16x32_bf16 v[196:199], v[68:71], v[44:47], v[196:199]
    ds_read_b128 v[44:47], v16 offset:12288
    v_mfma_f32_16x16x32_bf16 v[200:203], v[56:59], v[48:51], v[200:203]
    s_waitcnt lgkmcnt(1)
    v_cmp_gt_u32 vcc, s70, v7
    v_mfma_f32_16x16x32_bf16 v[204:207], v[60:63], v[48:51], v[204:207]
    v_mfma_f32_16x16x32_bf16 v[208:211], v[64:67], v[48:51], v[208:211]
    s_cbranch_vccnz L_spin_2
L_spinb_3:
    v_mfma_f32_16x16x32_bf16 v[212:215], v[68:71], v[48:51], v[212:215]
    ds_read_b128 v[48:51], v16 offset:14336
    v_mfma_f32_16x16x32_bf16 v[216:219], v[56:59], v[52:55], v[216:219]
    v_mfma_f32_16x16x32_bf16 v[220:223], v[60:63], v[52:55], v[220:223]
    v_mfma_f32_16x16x32_bf16 v[224:227], v[64:67], v[52:55], v[224:227]
    v_mfma_f32_16x16x32_bf16 v[228:231], v[68:71], v[52:55], v[228:231]
    ds_read_b128 v[52:55], v16 offset:16384
    v_mfma_f32_16x16x32_bf16 v[88:91], v[72:75], v[20:23], v[88:91]
    s_add_u32 s80, s80, 18432
    s_cmp_eq_u32 s80, 129024
    s_cselect_b32 s80, 73728, s80
    v_add_u32 v15, s80, v18
    v_mfma_f32_16x16x32_bf16 v[92:95], v[76:79], v[20:23], v[92:95]
    s_waitcnt vmcnt(9)
    ds_read_b64_tr_b16 v[56:57], v11 offset:0
    v_mfma_f32_16x16x32_bf16 v[96:99], v[80:83], v[20:23], v[96:99]
    ds_read_b64_tr_b16 v[58:59], v11 offset:512
    v_xor_b32 v16, 64, v15
    v_mfma_f32_16x16x32_bf16 v[100:103], v[84:87], v[20:23], v[100:103]
    ds_read_b128 v[20:23], v15 offset:0
    v_mfma_f32_16x16x32_bf16 v[104:107], v[72:75], v[24:27], v[104:107]
    ds_read_b64_tr_b16 v[60:61], v12 offset:0
    v_mfma_f32_16x16x32_bf16 v[108:111], v[76:79], v[24:27], v[108:111]
    ds_read_b64_tr_b16 v[62:63], v12 offset:512
    s_waitcnt lgkmcnt(5)
    v_mfma_f32_16x16x32_bf16 v[112:115], v[80:83], v[24:27], v[112:115]
    ds_inc_u32 v4, v5 offset:256
    v_mfma_f32_16x16x32_bf16 v[116:119], v[84:87], v[24:27], v[116:119]
    ds_read_b128 v[24:27], v15 offset:2048
    s_add_u32 s70, s70, 4
    v_mfma_f32_16x16x32_bf16 v[120:123], v[72:75], v[28:31], v[120:123]
    ds_read_b64_tr_b16 v[64:65], v13 offset:0
    v_mfma_f32_16x16x32_bf16 v[124:127], v[76:79], v[28:31], v[124:127]
    ds_read_b64_tr_b16 v[66:67], v13 offset:512
    v_mfma_f32_16x16x32_bf16 v[128:131], v[80:83], v[28:31], v[128:131]
    ds_read_b64_tr_b16 v[68:69], v14 offset:0
    v_mfma_f32_16x16x32_bf16 v[132:135], v[84:87], v[28:31], v[132:135]
    ds_read_b128 v[28:31], v15 offset:4096
    v_mfma_f32_16x16x32_bf16 v[136:139], v[72:75], v[32:35], v[136:139]
    ds_read_b64_tr_b16 v[70:71], v14 offset:512
    v_mfma_f32_16x16x32_bf16 v[140:143], v[76:79], v[32:35], v[140:143]
    v_mfma_f32_16x16x32_bf16 v[144:147], v[80:83], v[32:35], v[144:147]
    s_waitcnt lgkmcnt(0)
    s_add_u32 m0, s84, 0
    v_mfma_f32_16x16x32_bf16 v[148:151], v[84:87], v[32:35], v[148:151]
    ds_read_b128 v[32:35], v15 offset:6144
    v_mfma_f32_16x16x32_bf16 v[152:155], v[72:75], v[36:39], v[152:155]
    buffer_load_dwordx4 v9, s[44:47], s72 offen lds
    v_mfma_f32_16x16x32_bf16 v[156:159], v[76:79], v[36:39], v[156:159]
    s_add_u32 s72, s72, 65536
    s_add_u32 m0, s84, 1024
    v_mfma_f32_16x16x32_bf16 v[160:163], v[80:83], v[36:39], v[160:163]
    ds_read_b32 v7, v4 offset:256
    v_mfma_f32_16x16x32_bf16 v[164:167], v[84:87], v[36:39], v[164:167]
    ds_read_b128 v[36:39], v15 offset:8192
    v_mfma_f32_16x16x32_bf16 v[168:171], v[72:75], v[40:43], v[168:171]
    buffer_load_dwordx4 v10, s[44:47], s72 offen lds
    v_mfma_f32_16x16x32_bf16 v[172:175], v[76:79], v[40:43], v[172:175]
    s_add_u32 s72, s72, 65536
    s_waitcnt lgkmcnt(1)
    v_cmp_gt_u32 vcc, s70, v7
    s_add_u32 m0, s84, 2048
    v_mfma_f32_16x16x32_bf16 v[176:179], v[80:83], v[40:43], v[176:179]
    buffer_load_dwordx4 v9, s[44:47], s72 offen lds
    v_mfma_f32_16x16x32_bf16 v[180:183], v[84:87], v[40:43], v[180:183]
    ds_read_b128 v[40:43], v15 offset:10240
    s_add_u32 s72, s72, 65536
    v_mfma_f32_16x16x32_bf16 v[184:187], v[72:75], v[44:47], v[184:187]
    s_add_u32 m0, s84, 3072
    v_mfma_f32_16x16x32_bf16 v[188:191], v[76:79], v[44:47], v[188:191]
    buffer_load_dwordx4 v10, s[44:47], s72 offen lds
    v_mfma_f32_16x16x32_bf16 v[192:195], v[80:83], v[44:47], v[192:195]
    s_add_u32 s72, s72, 65536
    s_cmp_eq_u32 s72, s95
    s_cselect_b32 s72, s94, s72
    s_sub_u32 s93, s93, 1
    s_cselect_b32 s72, 1073741824, s72
    s_cselect_b32 s84, 0x30000, s84
    v_mfma_f32_16x16x32_bf16 v[196:199], v[84:87], v[44:47], v[196:199]
    ds_read_b128 v[44:47], v15 offset:12288
    v_mfma_f32_16x16x32_bf16 v[200:203], v[72:75], v[48:51], v[200:203]
    s_cbranch_vccnz L_spin_4
L_spinb_5:
    v_mfma_f32_16x16x32_bf16 v[204:207], v[76:79], v[48:51], v[204:207]
    s_add_u32 m0, s79, s83
    s_add_u32 s75, s71, s81
    v_mfma_f32_16x16x32_bf16 v[208:211], v[80:83], v[48:51], v[208:211]
    buffer_load_dwordx4 v8, s[32:35], s75 offen lds
    v_mfma_f32_16x16x32_bf16 v[212:215], v[84:87], v[48:51], v[212:215]
    ds_read_b128 v[48:51], v15 offset:14336
    s_add_u32 m0, m0, 1024
    v_mfma_f32_16x16x32_bf16 v[216:219], v[72:75], v[52:55], v[216:219]
    s_add_u32 s75, s75, 9216
    v_mfma_f32_16x16x32_bf16 v[220:223], v[76:79], v[52:55], v[220:223]
    buffer_load_dwordx4 v8, s[32:35], s75 offen lds
    v_mfma_f32_16x16x32_bf16 v[224:227], v[80:83], v[52:55], v[224:227]
    s_add_u32 m0, m0, 1024
    s_add_u32 s75, s75, 9216
    v_mfma_f32_16x16x32_bf16 v[228:231], v[84:87], v[52:55], v[228:231]
    ds_read_b128 v[52:55], v15 offset:16384
    buffer_load_dwordx4 v8, s[32:35], s75 offen lds
    s_add_u32 m0, m0, 1024
    s_add_u32 s75, s75, 9216
    buffer_load_dwordx4 v8, s[32:35], s75 offen lds
    s_add_u32 m0, s79, s76
    s_add_u32 s75, s78, s81
    s_mov_b64 exec, s[86:87]
    buffer_load_dwordx4 v8, s[32:35], s75 offen lds
    s_mov_b64 exec, -1
    s_add_u32 s81, s81, 128
    s_cmp_eq_u32 s81, 1152
    s_cselect_b32 s81, 0, s81
    s_sub_u32 s92, s92, 1
    s_cselect_b32 s81, 1073741824, s81
    s_cselect_b32 s83, 0x18000, s83
    s_cselect_b32 s76, 0x18000, s76
    s_add_u32 s79, s79, 18432
    s_cmp_eq_u32 s79, 129024
    s_cselect_b32 s79, 73728, s79
    s_sub_u32 s82, s82, 1
    s_cmp_lg_u32 s82, 0
    s_nop 1
    s_cbranch_scc1 L_G_loop
    s_waitcnt lgkmcnt(0)
    s_add_u32 s70, s70, 4
    ds_inc_u32 v4, v5 offset:256
    v_add_u32 v1, s74, v17
    s_lshr_b32 s76, s65, 1
    s_add_u32 s76, s76, s73
    s_cmp_eq_u32 s76, 1
    s_cselect_b32 s75, 65536, s74
    v_add_u32 v2, s75, v17
    s_cmp_eq_u32 s76, 2
    s_cselect_b32 s75, 139264, s74
    v_add_u32 v3, s75, v17
    v_mov_b32 v20, s77
    v_mov_b32 v21, s77
    v_pk_mul_f32 v[88:89], v[88:89], v[20:21]
    v_pk_mul_f32 v[90:91], v[90:91], v[20:21]
    v_cvt_pk_bf16_f32 v88, v88, v89
    v_cvt_pk_bf16_f32 v89, v90, v91
    v_pk_mul_f32 v[92:93], v[92:93], v[20:21]
    v_pk_mul_f32 v[94:95], v[94:95], v[20:21]
    v_cvt_pk_bf16_f32 v92, v92, v93
    v_cvt_pk_bf16_f32 v93, v94, v95
    v_pk_mul_f32 v[96:97], v[96:97], v[20:21]
    v_pk_mul_f32 v[98:99], v[98:99], v[20:21]
    v_cvt_pk_bf16_f32 v96, v96, v97
    v_cvt_pk_bf16_f32 v97, v98, v99
    v_pk_mul_f32 v[100:101], v[100:101], v[20:21]
    v_pk_mul_f32 v[102:103], v[102:103], v[20:21]
    v_cvt_pk_bf16_f32 v100, v100, v101
    v_cvt_pk_bf16_f32 v101, v102, v103
    v_pk_mul_f32 v[104:105], v[104:105], v[20:21]
    v_pk_mul_f32 v[106:107], v[106:107], v[20:21]
    v_cvt_pk_bf16_f32 v104, v104, v105
    v_cvt_pk_bf16_f32 v105, v106, v107
    v_pk_mul_f32 v[108:109], v[108:109], v[20:21]
    v_pk_mul_f32 v[110:111], v[110:111], v[20:21]
    v_cvt_pk_bf16_f32 v108, v108, v109
    v_cvt_pk_bf16_f32 v109, v110, v111
L_fw_6:
    s_sub_u32 s90, s90, 1
    s_cbranch_scc1 L_bail
    ds_read_b32 v7, v4 offset:256
    s_waitcnt lgkmcnt(0)
    v_cmp_gt_u32 vcc, s70, v7
    s_cbranch_vccnz L_fw_6
    ds_write_b64 v2, v[88:89] offset:0
    v_pk_mul_f32 v[112:113], v[112:113], v[20:21]
    v_pk_mul_f32 v[114:115], v[114:115], v[20:21]
    v_cvt_pk_bf16_f32 v112, v112, v113
    v_cvt_pk_bf16_f32 v113, v114, v115
    ds_write_b64 v2, v[92:93] offset:512
    v_pk_mul_f32 v[116:117], v[116:117], v[20:21]
    v_pk_mul_f32 v[118:119], v[118:119], v[20:21]
    v_cvt_pk_bf16_f32 v116, v116, v117
    v_cvt_pk_bf16_f32 v117, v118, v119
    ds_write_b64 v2, v[96:97] offset:1024
    v_pk_mul_f32 v[120:121], v[120:121], v[20:21]
    v_pk_mul_f32 v[122:123], v[122:123], v[20:21]
    v_cvt_pk_bf16_f32 v120, v120, v121
    v_cvt_pk_bf16_f32 v121, v122, v123
    ds_write_b64 v2, v[100:101] offset:1536
    v_pk_mul_f32 v[124:125], v[124:125], v[20:21]
    v_pk_mul_f32 v[126:127], v[126:127], v[20:21]
    v_cvt_pk_bf16_f32 v124, v124, v125
    v_cvt_pk_bf16_f32 v125, v126, v127
    ds_write_b64 v2, v[104:105] offset:4096
    v_pk_mul_f32 v[128:129], v[128:129], v[20:21]
    v_pk_mul_f32 v[130:131], v[130:131], v[20:21]
    v_cvt_pk_bf16_f32 v128, v128, v129
    v_cvt_pk_bf16_f32 v129, v130, v131
    ds_write_b64 v2, v[108:109] offset:4608
    v_pk_mul_f32 v[132:133], v[132:133], v[20:21]
    v_pk_mul_f32 v[134:135], v[134:135], v[20:21]
    v_cvt_pk_bf16_f32 v132, v132, v133
    v_cvt_pk_bf16_f32 v133, v134, v135
    ds_write_b64 v2, v[112:113] offset:5120
    v_pk_mul_f32 v[136:137], v[136:137], v[20:21]
    v_pk_mul_f32 v[138:139], v[138:139], v[20:21]
    v_cvt_pk_bf16_f32 v136, v136, v137
    v_cvt_pk_bf16_f32 v137, v138, v139
    ds_write_b64 v2, v[116:117] offset:5632
    v_pk_mul_f32 v[140:141], v[140:141], v[20:21]
    v_pk_mul_f32 v[142:143], v[142:143], v[20:21]
    v_cvt_pk_bf16_f32 v140, v140, v141
    v_cvt_pk_bf16_f32 v141, v142, v143
    ds_write_b64 v3, v[120:121] offset:8192
    v_pk_mul_f32 v[144:145], v[144:145], v[20:21]
    v_pk_mul_f32 v[146:147], v[146:147], v[20:21]
    v_cvt_pk_bf16_f32 v144, v144, v145
    v_cvt_pk_bf16_f32 v145, v146, v147
    ds_write_b64 v3, v[124:125] offset:8704
    v_pk_mul_f32 v[148:149], v[148:149], v[20:21]
    v_pk_mul_f32 v[150:151], v[150:151], v[20:21]
    v_cvt_pk_bf16_f32 v148, v148, v149
    v_cvt_pk_bf16_f32 v149, v150, v151
    ds_write_b64 v3, v[128:129] offset:9216
    v_pk_mul_f32 v[152:153], v[152:153], v[20:21]
    v_pk_mul_f32 v[154:155], v[154:155], v[20:21]
    v_cvt_pk_bf16_f32 v152, v152, v153
    v_cvt_pk_bf16_f32 v153, v154, v155
    ds_write_b64 v3, v[132:133] offset:9728
    v_pk_mul_f32 v[156:157], v[156:157], v[20:21]
    v_pk_mul_f32 v[158:159], v[158:159], v[20:21]
    v_cvt_pk_bf16_f32 v156, v156, v157
    v_cvt_pk_bf16_f32 v157, v158, v159
    ds_write_b64 v3, v[136:137] offset:12288
    v_pk_mul_f32 v[160:161], v[160:161], v[20:21]
    v_pk_mul_f32 v[162:163], v[162:163], v[20:21]
    v_cvt_pk_bf16_f32 v160, v160, v161
    v_cvt_pk_bf16_f32 v161, v162, v163
    ds_write_b64 v3, v[140:141] offset:12800
    v_pk_mul_f32 v[164:165], v[164:165], v[20:21]
    v_pk_mul_f32 v[166:167], v[166:167], v[20:21]
    v_cvt_pk_bf16_f32 v164, v164, v165
    v_cvt_pk_bf16_f32 v165, v166, v167
    ds_write_b64 v3, v[144:145] offset:13312
    v_pk_mul_f32 v[168:169], v[168:169], v[20:21]
    v_pk_mul_f32 v[170:171], v[170:171], v[20:21]
    v_cvt_pk_bf16_f32 v168, v168, v169
    v_cvt_pk_bf16_f32 v169, v170, v171
    ds_write_b64 v3, v[148:149] offset:13824
    v_pk_mul_f32 v[172:173], v[172:173], v[20:21]
    v_pk_mul_f32 v[174:175], v[174:175], v[20:21]
    v_cvt_pk_bf16_f32 v172, v172, v173
    v_cvt_pk_bf16_f32 v173, v174, v175
    ds_write_b64 v1, v[152:153] offset:16384
    v_pk_mul_f32 v[176:177], v[176:177], v[20:21]
    v_pk_mul_f32 v[178:179], v[178:179], v[20:21]
    v_cvt_pk_bf16_f32 v176, v176, v177
    v_cvt_pk_bf16_f32 v177, v178, v179
    ds_write_b64 v1, v[156:157] offset:16896
    v_pk_mul_f32 v[180:181], v[180:181], v[20:21]
    v_pk_mul_f32 v[182:183], v[182:183], v[20:21]
    v_cvt_pk_bf16_f32 v180, v180, v181
    v_cvt_pk_bf16_f32 v181, v182, v183
    ds_write_b64 v1, v[160:161] offset:17408
    v_pk_mul_f32 v[184:185], v[184:185], v[20:21]
    v_pk_mul_f32 v[186:187], v[186:187], v[20:21]
    v_cvt_pk_bf16_f32 v184, v184, v185
    v_cvt_pk_bf16_f32 v185, v186, v187
    ds_write_b64 v1, v[164:165] offset:17920
    v_pk_mul_f32 v[188:189], v[188:189], v[20:21]
    v_pk_mul_f32 v[190:191], v[190:191], v[20:21]
    v_cvt_pk_bf16_f32 v188, v188, v189
    v_cvt_pk_bf16_f32 v189, v190, v191
    ds_write_b64 v1, v[168:169] offset:20480
    v_pk_mul_f32 v[192:193], v[192:193], v[20:21]
    v_pk_mul_f32 v[194:195], v[194:195], v[20:21]
    v_cvt_pk_bf16_f32 v192, v192, v193
    v_cvt_pk_bf16_f32 v193, v194, v195
    ds_write_b64 v1, v[172:173] offset:20992
    v_pk_mul_f32 v[196:197], v[196:197], v[20:21]
    v_pk_mul_f32 v[198:199], v[198:199], v[20:21]
    v_cvt_pk_bf16_f32 v196, v196, v197
    v_cvt_pk_bf16_f32 v197, v198, v199
    ds_write_b64 v1, v[176:177] offset:21504
    v_pk_mul_f32 v[200:201], v[200:201], v[20:21]
    v_pk_mul_f32 v[202:203], v[202:203], v[20:21]
    v_cvt_pk_bf16_f32 v200, v200, v201
    v_cvt_pk_bf16_f32 v201, v202, v203
    ds_write_b64 v1, v[180:181] offset:22016
    v_pk_mul_f32 v[204:205], v[204:205], v[20:21]
    v_pk_mul_f32 v[206:207], v[206:207], v[20:21]
    v_cvt_pk_bf16_f32 v204, v204, v205
    v_cvt_pk_bf16_f32 v205, v206, v207
    ds_write_b64 v1, v[184:185] offset:24576
    v_pk_mul_f32 v[208:209], v[208:209], v[20:21]
    v_pk_mul_f32 v[210:211], v[210:211], v[20:21]
    v_cvt_pk_bf16_f32 v208, v208, v209
    v_cvt_pk_bf16_f32 v209, v210, v211
    ds_write_b64 v1, v[188:189] offset:25088
    v_pk_mul_f32 v[212:213], v[212:213], v[20:21]
    v_pk_mul_f32 v[214:215], v[214:215], v[20:21]
    v_cvt_pk_bf16_f32 v212, v212, v213
    v_cvt_pk_bf16_f32 v213, v214, v215
    ds_write_b64 v1, v[192:193] offset:25600
    v_pk_mul_f32 v[216:217], v[216:217], v[20:21]
    v_pk_mul_f32 v[218:219], v[218:219], v[20:21]
    v_cvt_pk_bf16_f32 v216, v216, v217
    v_cvt_pk_bf16_f32 v217, v218, v219
    ds_write_b64 v1, v[196:197] offset:26112
    v_pk_mul_f32 v[220:221], v[220:221], v[20:21]
    v_pk_mul_f32 v[222:223], v[222:223], v[20:21]
    v_cvt_pk_bf16_f32 v220, v220, v221
    v_cvt_pk_bf16_f32 v221, v222, v223
    ds_write_b64 v1, v[200:201] offset:28672
    v_pk_mul_f32 v[224:225], v[224:225], v[20:21]
    v_pk_mul_f32 v[226:227], v[226:227], v[20:21]
    v_cvt_pk_bf16_f32 v224, v224, v225
    v_cvt_pk_bf16_f32 v225, v226, v227
    ds_write_b64 v1, v[204:205] offset:29184
    v_pk_mul_f32 v[228:229], v[228:229], v[20:21]
    v_pk_mul_f32 v[230:231], v[230:231], v[20:21]
    v_cvt_pk_bf16_f32 v228, v228, v229
    v_cvt_pk_bf16_f32 v229, v230, v231
    ds_write_b64 v1, v[208:209] offset:29696
    ds_write_b64 v1, v[212:213] offset:30208
    ds_write_b64 v1, v[216:217] offset:32768
    ds_write_b64 v1, v[220:221] offset:33280
    ds_write_b64 v1, v[224:225] offset:33792
    ds_write_b64 v1, v[228:229] offset:34304
    s_add_u32 s73, s73, 2
    s_waitcnt lgkmcnt(0)
    ds_inc_u32 v4, v5 offset:512
    s_mov_b32 s76, 4
L_fw_7:
    s_sleep 1
    s_sub_u32 s90, s90, 1
    s_cbranch_scc1 L_bail
    ds_read_b32 v7, v4 offset:768
    s_waitcnt lgkmcnt(0)
    v_cmp_gt_u32 vcc, s76, v7
    s_cbranch_vccnz L_fw_7
    s_add_u32 s94, s94, 512
    s_cmp_lt_u32 s73, 4
    s_nop 1
    s_cbranch_scc1 L_G_task
    s_lshr_b32 s78, s68, 1
    s_and_b32 s77, s68, 1
    v_lshlrev_b32 v1, 4, v0
    s_lshl_b32 s75, s77, 12
    v_add_u32 v4, s75, v1
    v_add_u32 v5, 4096, v4
    s_cmp_eq_u32 s77, 0
    s_cselect_b32 s75, 5120, 0
    v_add_u32 v6, s75, v1
    v_lshrrev_b32 v2, 4, v0
    v_lshlrev_b32 v2, 1, v2
    v_and_b32 v1, 7, v0
    v_xor_b32 v1, v1, v2
    v_lshrrev_b32 v3, 3, v0
    v_mul_u32_u24 v7, 1152, v3
    v_lshl_add_u32 v7, v1, 4, v7
    s_lshl_b32 s75, s68, 7
    v_add_u32 v7, s75, v7
    v_lshlrev_b32 v8, 4, v0
    s_lshl_b32 s75, s69, 2
    s_add_u32 s75, s75, s78
    s_lshl_b32 s75, s75, 17
    s_add_u32 s75, s75, 41999872
    v_add_u32 v8, s75, v8
    s_mov_b32 s97, 0x1c71c71d
    s_mul_i32 s74, s65, 11264
    s_add_u32 s74, s74, 65536
    v_lshrrev_b32 v1, 2, v0
    v_lshlrev_b32 v9, 7, v1
    v_bfe_u32 v3, v0, 3, 2
    v_lshl_add_u32 v9, v3, 5, v9
    v_and_b32 v3, 3, v0
    v_lshl_add_u32 v9, v3, 3, v9
    v_xor_b32 v10, 32, v9
    v_xor_b32 v11, 64, v9
    v_xor_b32 v12, 96, v9
    v_add_u32 v9, s74, v9
    v_add_u32 v10, s74, v10
    v_add_u32 v11, s74, v11
    v_add_u32 v12, s74, v12
    v_lshlrev_b32 v13, 3, v0
    v_add_u32 v13, s74, v13
    s_lshl_b32 s75, s66, 2
    s_add_u32 s75, s75, s65
    s_mul_i32 s71, s75, 294912
    s_mul_i32 s72, s65, 1179648
    s_and_b32 s79, s65, 1
    s_lshl_b32 s79, s79, 4
    s_mov_b32 s73, 0
    s_add_u32 s75, s96, 0
    s_and_b32 s76, s75, 3
    s_mul_i32 s6, s76, 9216
    s_bitcmp1_b32 s75, 2
    s_cselect_b32 s75, 147456, 0
    s_add_u32 s6, s6, s75
    s_add_u32 s75, s96, 1
    s_and_b32 s76, s75, 3
    s_mul_i32 s7, s76, 9216
    s_bitcmp1_b32 s75, 2
    s_cselect_b32 s75, 147456, 0
    s_add_u32 s7, s7, s75
    s_add_u32 s75, s96, 2
    s_and_b32 s76, s75, 3
    s_mul_i32 s8, s76, 9216
    s_bitcmp1_b32 s75, 2
    s_cselect_b32 s75, 147456, 0
    s_add_u32 s8, s8, s75
    s_add_u32 s75, s96, 3
    s_and_b32 s76, s75, 3
    s_mul_i32 s9, s76, 9216
    s_bitcmp1_b32 s75, 2
    s_cselect_b32 s75, 147456, 0
    s_add_u32 s9, s9, s75
    s_add_u32 s75, s96, 4
    s_and_b32 s76, s75, 3
    s_mul_i32 s10, s76, 9216
    s_bitcmp1_b32 s75, 2
    s_cselect_b32 s75, 147456, 0
    s_add_u32 s10, s10, s75
    s_add_u32 s75, s96, 5
    s_and_b32 s76, s75, 3
    s_mul_i32 s11, s76, 9216
    s_bitcmp1_b32 s75, 2
    s_cselect_b32 s75, 147456, 0
    s_add_u32 s11, s11, s75
    s_add_u32 s75, s96, 6
    s_and_b32 s76, s75, 3
    s_mul_i32 s12, s76, 9216
    s_bitcmp1_b32 s75, 2
    s_cselect_b32 s75, 147456, 0
    s_add_u32 s12, s12, s75
    s_add_u32 s75, s96, 7
    s_and_b32 s76, s75, 3
    s_mul_i32 s13, s76, 9216
    s_bitcmp1_b32 s75, 2
    s_cselect_b32 s75, 147456, 0
    s_add_u32 s13, s13, s75
    s_lshl_b32 s75, s69, 7
    v_mov_b32 v2, s75
L_O_init:
    s_sub_u32 s90, s90, 1
    s_cbranch_scc1 L_bail
    buffer_load_dword v1, v2, s[56:59], 0 offen sc1
    s_waitcnt vmcnt(0)
    v_cmp_gt_u32 vcc, 0x80, v1
    s_cbranch_vccnz L_O_init
    v_mov_b32 v92, 0
    v_mov_b32 v93, 0
    v_mov_b32 v94, 0
    v_mov_b32 v95, 0
    v_mov_b32 v96, 0
    v_mov_b32 v97, 0
    v_mov_b32 v98, 0
    v_mov_b32 v99, 0
    v_mov_b32 v100, 0
    v_mov_b32 v101, 0
    v_mov_b32 v102, 0
    v_mov_b32 v103, 0
    v_mov_b32 v104, 0
    v_mov_b32 v105, 0
    v_mov_b32 v106, 0
    v_mov_b32 v107, 0
    v_mov_b32 v108, 0
    v_mov_b32 v109, 0
    v_mov_b32 v110, 0
    v_mov_b32 v111, 0
    v_mov_b32 v112, 0
    v_mov_b32 v113, 0
    v_mov_b32 v114, 0
    v_mov_b32 v115, 0
    v_mov_b32 v116, 0
    v_mov_b32 v117, 0
    v_mov_b32 v118, 0
    v_mov_b32 v119, 0
    v_mov_b32 v120, 0
    v_mov_b32 v121, 0
    v_mov_b32 v122, 0
    v_mov_b32 v123, 0
    v_mov_b32 v124, 0
    v_mov_b32 v125, 0
    v_mov_b32 v126, 0
    v_mov_b32 v127, 0
    v_mov_b32 v128, 0
    v_mov_b32 v129, 0
    v_mov_b32 v130, 0
    v_mov_b32 v131, 0
    v_mov_b32 v132, 0
    v_mov_b32 v133, 0
    v_mov_b32 v134, 0
    v_mov_b32 v135, 0
    v_mov_b32 v136, 0
    v_mov_b32 v137, 0
    v_mov_b32 v138, 0
    v_mov_b32 v139, 0
    v_mov_b32 v140, 0
    v_mov_b32 v141, 0
    v_mov_b32 v142, 0
    v_mov_b32 v143, 0
    v_mov_b32 v144, 0
    v_mov_b32 v145, 0
    v_mov_b32 v146, 0
    v_mov_b32 v147, 0
    v_mov_b32 v148, 0
    v_mov_b32 v149, 0
    v_mov_b32 v150, 0
    v_mov_b32 v151, 0
    v_mov_b32 v152, 0
    v_mov_b32 v153, 0
    v_mov_b32 v154, 0
    v_mov_b32 v155, 0
    v_mov_b32 v156, 0
    v_mov_b32 v157, 0
    v_mov_b32 v158, 0
    v_mov_b32 v159, 0
    v_mov_b32 v160, 0
    v_mov_b32 v161, 0
    v_mov_b32 v162, 0
    v_mov_b32 v163, 0
    v_mov_b32 v164, 0
    v_mov_b32 v165, 0
    v_mov_b32 v166, 0
    v_mov_b32 v167, 0
    v_mov_b32 v168, 0
    v_mov_b32 v169, 0
    v_mov_b32 v170, 0
    v_mov_b32 v171, 0
    v_mov_b32 v172, 0
    v_mov_b32 v173, 0
    v_mov_b32 v174, 0
    v_mov_b32 v175, 0
    v_mov_b32 v176, 0
    v_mov_b32 v177, 0
    v_mov_b32 v178, 0
    v_mov_b32 v179, 0
    v_mov_b32 v180, 0
    v_mov_b32 v181, 0
    v_mov_b32 v182, 0
    v_mov_b32 v183, 0
    v_mov_b32 v184, 0
    v_mov_b32 v185, 0
    v_mov_b32 v186, 0
    v_mov_b32 v187, 0
    v_mov_b32 v188, 0
    v_mov_b32 v189, 0
    v_mov_b32 v190, 0
    v_mov_b32 v191, 0
    v_mov_b32 v192, 0
    v_mov_b32 v193, 0
    v_mov_b32 v194, 0
    v_mov_b32 v195, 0
    v_mov_b32 v196, 0
    v_mov_b32 v197, 0
    v_mov_b32 v198, 0
    v_mov_b32 v199, 0
    v_mov_b32 v200, 0
    v_mov_b32 v201, 0
    v_mov_b32 v202, 0
    v_mov_b32 v203, 0
    v_mov_b32 v204, 0
    v_mov_b32 v205, 0
    v_mov_b32 v206, 0
    v_mov_b32 v207, 0
    v_mov_b32 v208, 0
    v_mov_b32 v209, 0
    v_mov_b32 v210, 0
    v_mov_b32 v211, 0
    v_mov_b32 v212, 0
    v_mov_b32 v213, 0
    v_mov_b32 v214, 0
    v_mov_b32 v215, 0
    v_mov_b32 v216, 0
    v_mov_b32 v217, 0
    v_mov_b32 v218, 0
    v_mov_b32 v219, 0
    v_mov_b32 v220, 0
    v_mov_b32 v221, 0
    v_mov_b32 v222, 0
    v_mov_b32 v223, 0
    v_mov_b32 v224, 0
    v_mov_b32 v225, 0
    v_mov_b32 v226, 0
    v_mov_b32 v227, 0
    v_mov_b32 v228, 0
    v_mov_b32 v229, 0
    v_mov_b32 v230, 0
    v_mov_b32 v231, 0
    v_mov_b32 v232, 0
    v_mov_b32 v233, 0
    v_mov_b32 v234, 0
    v_mov_b32 v235, 0
    v_mov_b32 v236, 0
    v_mov_b32 v237, 0
    v_mov_b32 v238, 0
    v_mov_b32 v239, 0
    v_mov_b32 v240, 0
    v_mov_b32 v241, 0
    v_mov_b32 v242, 0
    v_mov_b32 v243, 0
    v_mov_b32 v244, 0
    v_mov_b32 v245, 0
    v_mov_b32 v246, 0
    v_mov_b32 v247, 0
    v_mov_b32 v248, 0
    v_mov_b32 v249, 0
    v_mov_b32 v250, 0
    v_mov_b32 v251, 0
    v_mov_b32 v252, 0
    v_mov_b32 v253, 0
    v_mov_b32 v254, 0
    v_mov_b32 v255, 0
    s_lshl_b32 s75, s66, 3
    s_lshl_b32 s76, s65, 1
    s_add_u32 s75, s75, s76
    s_lshl_b32 s75, s75, 8
    s_add_u32 s75, s75, 40000000
    v_and_b32 v14, 1, v0
    v_lshlrev_b32 v14, 8, v14
    v_add_u32 v14, s75, v14
    v_mov_b32 v3, 162816
    s_mov_b32 s76, 8
    v_mov_b32 v15, 162560
L_fw_8:
    s_sleep 1
    s_sub_u32 s90, s90, 1
    s_cbranch_scc1 L_bail
    ds_read_b32 v1, v15 offset:0
    s_waitcnt lgkmcnt(0)
    v_cmp_gt_u32 vcc, s76, v1
    s_cbranch_vccnz L_fw_8
    s_lshl2_add_u32 s75, s6, s72
    s_add_u32 m0, s74, 4096
    s_lshr_b32 s85, s75, 12
    s_mul_hi_u32 s85, s85, s97
    s_lshl_b32 s85, s85, 10
    buffer_load_dwordx4 v8, s[60:63], s85 offen sc1 lds
    s_add_u32 m0, s74, 0
    s_nop 0
    buffer_load_dwordx4 v7, s[48:51], s75 offen lds
    s_add_u32 s75, s75, 9216
    s_add_u32 m0, s74, 1024
    s_nop 0
    buffer_load_dwordx4 v7, s[48:51], s75 offen lds
    s_add_u32 s75, s75, 9216
    s_add_u32 m0, s74, 2048
    s_nop 0
    buffer_load_dwordx4 v7, s[48:51], s75 offen lds
    s_add_u32 s75, s75, 9216
    s_add_u32 m0, s74, 3072
    s_nop 0
    buffer_load_dwordx4 v7, s[48:51], s75 offen lds
    s_lshl2_add_u32 s75, s7, s72
    s_add_u32 m0, s74, 9216
    s_lshr_b32 s85, s75, 12
    s_mul_hi_u32 s85, s85, s97
    s_lshl_b32 s85, s85, 10
    buffer_load_dwordx4 v8, s[60:63], s85 offen sc1 lds
    s_add_u32 m0, s74, 5120
    s_nop 0
    buffer_load_dwordx4 v7, s[48:51], s75 offen lds
    s_add_u32 s75, s75, 9216
    s_add_u32 m0, s74, 6144
    s_nop 0
    buffer_load_dwordx4 v7, s[48:51], s75 offen lds
    s_add_u32 s75, s75, 9216
    s_add_u32 m0, s74, 7168
    s_nop 0
    buffer_load_dwordx4 v7, s[48:51], s75 offen lds
    s_add_u32 s75, s75, 9216
    s_add_u32 m0, s74, 8192
    s_nop 0
    buffer_load_dwordx4 v7, s[48:51], s75 offen lds
    buffer_load_dword v2, v14, s[60:63], 0 offen sc1
    s_waitcnt vmcnt(6)
    ds_read_b64_tr_b16 v[52:53], v9 offset:0
    ds_read_b64_tr_b16 v[54:55], v9 offset:2048
    ds_read_b64_tr_b16 v[56:57], v10 offset:0
    ds_read_b64_tr_b16 v[58:59], v10 offset:2048
    ds_read_b64_tr_b16 v[60:61], v11 offset:0
    ds_read_b64_tr_b16 v[62:63], v11 offset:2048
    ds_read_b64_tr_b16 v[64:65], v12 offset:0
    ds_read_b64_tr_b16 v[66:67], v12 offset:2048
    ds_read_b64_tr_b16 v[68:69], v13 offset:4096
    ds_read_b64_tr_b16 v[70:71], v13 offset:4608
    s_waitcnt lgkmcnt(0)
    s_lshl2_add_u32 s75, s8, s72
    s_add_u32 m0, s74, 4096
    s_lshr_b32 s85, s75, 12
    s_mul_hi_u32 s85, s85, s97
    s_lshl_b32 s85, s85, 10
    buffer_load_dwordx4 v8, s[60:63], s85 offen sc1 lds
    s_add_u32 m0, s74, 0
    s_nop 0
    buffer_load_dwordx4 v7, s[48:51], s75 offen lds
    s_add_u32 s75, s75, 9216
    s_add_u32 m0, s74, 1024
    s_nop 0
    buffer_load_dwordx4 v7, s[48:51], s75 offen lds
    s_add_u32 s75, s75, 9216
    s_add_u32 m0, s74, 2048
    s_nop 0
    buffer_load_dwordx4 v7, s[48:51], s75 offen lds
    s_add_u32 s75, s75, 9216
    s_add_u32 m0, s74, 3072
    s_nop 0
    buffer_load_dwordx4 v7, s[48:51], s75 offen lds
    s_waitcnt vmcnt(5)
    v_cmp_ge_u32 vcc, s73, v2
    s_cbranch_vccz L_O_go
    s_nop 3
.p2align 6
L_O_task:
    s_add_u32 s75, s73, 1
L_fw_9:
    s_sleep 4
    s_sub_u32 s90, s90, 1
    s_cbranch_scc1 L_bail
    ds_read_b32 v1, v3 offset:0
    s_waitcnt lgkmcnt(0)
    v_cmp_gt_u32 vcc, s75, v1
    s_cbranch_vccnz L_fw_9
L_O_poll:
    s_sub_u32 s90, s90, 1
    s_cbranch_scc1 L_bail
    buffer_load_dword v1, v14, s[60:63], 0 offen sc1
    s_waitcnt vmcnt(0)
    v_cmp_gt_u32 vcc, s75, v1
    s_cbranch_vccz L_O_go
    s_sleep 8
    s_branch L_O_poll
L_O_go:
    ds_read_b32 v1, v3
    s_waitcnt lgkmcnt(0)
    v_cmp_eq_u32 vcc, 4, v1
    s_cbranch_vccnz L_O_free
    s_add_u32 s76, s71, s6
    s_waitcnt vmcnt(5)
    buffer_load_dwordx4 v[16:19], v4, s[60:63], s76 offen offset:0 sc1
    s_waitcnt vmcnt(5)
    buffer_load_dwordx4 v[20:23], v4, s[60:63], s76 offen offset:1024 sc1
    s_waitcnt vmcnt(5)
    buffer_load_dwordx4 v[24:27], v4, s[60:63], s76 offen offset:2048 sc1
    s_waitcnt vmcnt(5)
    buffer_load_dwordx4 v[28:31], v4, s[60:63], s76 offen offset:3072 sc1
    s_waitcnt vmcnt(5)
    buffer_load_dwordx4 v[32:35], v5, s[60:63], s76 offen sc1
    s_waitcnt vmcnt(5)
    buffer_load_dwordx4 v[36:39], v6, s[60:63], s76 offen offset:0 sc1
    s_waitcnt vmcnt(5)
    buffer_load_dwordx4 v[40:43], v6, s[60:63], s76 offen offset:1024 sc1
    s_waitcnt vmcnt(5)
    buffer_load_dwordx4 v[44:47], v6, s[60:63], s76 offen offset:2048 sc1
    s_waitcnt vmcnt(5)
    buffer_load_dwordx4 v[48:51], v6, s[60:63], s76 offen offset:3072 sc1
    s_waitcnt lgkmcnt(0)
    v_mfma_f32_16x16x32_bf16 v[92:95], v[52:55], v[16:19], v[92:95]
    s_add_u32 s76, s71, s7
    v_mfma_f32_16x16x32_bf16 v[96:99], v[56:59], v[16:19], v[96:99]
    ds_read_b64_tr_b16 v[72:73], v9 offset:5120
    v_mfma_f32_16x16x32_bf16 v[100:103], v[60:63], v[16:19], v[100:103]
    ds_read_b64_tr_b16 v[74:75], v9 offset:7168
    v_mfma_f32_16x16x32_bf16 v[104:107], v[64:67], v[16:19], v[104:107]
    ds_read_b64_tr_b16 v[76:77], v10 offset:5120
    v_mfma_f32_16x16x32_bf16 v[108:111], v[68:71], v[16:19], v[108:111]
    s_waitcnt vmcnt(5)
    buffer_load_dwordx4 v[16:19], v4, s[60:63], s76 offen offset:0 sc1
    v_mfma_f32_16x16x32_bf16 v[112:115], v[52:55], v[20:23], v[112:115]
    ds_read_b64_tr_b16 v[78:79], v10 offset:7168
    v_mfma_f32_16x16x32_bf16 v[116:119], v[56:59], v[20:23], v[116:119]
    ds_read_b64_tr_b16 v[80:81], v11 offset:5120
    v_mfma_f32_16x16x32_bf16 v[120:123], v[60:63], v[20:23], v[120:123]
    ds_read_b64_tr_b16 v[82:83], v11 offset:7168
    v_mfma_f32_16x16x32_bf16 v[124:127], v[64:67], v[20:23], v[124:127]
    ds_read_b64_tr_b16 v[84:85], v12 offset:5120
    v_mfma_f32_16x16x32_bf16 v[128:131], v[68:71], v[20:23], v[128:131]
    s_waitcnt vmcnt(5)
    buffer_load_dwordx4 v[20:23], v4, s[60:63], s76 offen offset:1024 sc1
    v_mfma_f32_16x16x32_bf16 v[132:135], v[52:55], v[24:27], v[132:135]
    ds_read_b64_tr_b16 v[86:87], v12 offset:7168
    v_mfma_f32_16x16x32_bf16 v[136:139], v[56:59], v[24:27], v[136:139]
    ds_read_b64_tr_b16 v[88:89], v13 offset:9216
    v_mfma_f32_16x16x32_bf16 v[140:143], v[60:63], v[24:27], v[140:143]
    ds_read_b64_tr_b16 v[90:91], v13 offset:9728
    v_mfma_f32_16x16x32_bf16 v[144:147], v[64:67], v[24:27], v[144:147]
    v_mfma_f32_16x16x32_bf16 v[148:151], v[68:71], v[24:27], v[148:151]
    s_waitcnt vmcnt(5)
    buffer_load_dwordx4 v[24:27], v4, s[60:63], s76 offen offset:2048 sc1
    v_mfma_f32_16x16x32_bf16 v[152:155], v[52:55], v[28:31], v[152:155]
    v_mfma_f32_16x16x32_bf16 v[156:159], v[56:59], v[28:31], v[156:159]
    v_mfma_f32_16x16x32_bf16 v[160:163], v[60:63], v[28:31], v[160:163]
    v_mfma_f32_16x16x32_bf16 v[164:167], v[64:67], v[28:31], v[164:167]
    s_waitcnt lgkmcnt(0)
    s_lshl2_add_u32 s75, s9, s72
    s_add_u32 m0, s74, 9216
    v_mfma_f32_16x16x32_bf16 v[168:171], v[68:71], v[28:31], v[168:171]
    s_waitcnt vmcnt(5)
    buffer_load_dwordx4 v[28:31], v4, s[60:63], s76 offen offset:3072 sc1
    v_mfma_f32_16x16x32_bf16 v[172:175], v[52:55], v[32:35], v[172:175]
    s_lshr_b32 s85, s75, 12
    s_mul_hi_u32 s85, s85, s97
    s_lshl_b32 s85, s85, 10
    v_mfma_f32_16x16x32_bf16 v[176:179], v[56:59], v[32:35], v[176:179]
    s_waitcnt vmcnt(5)
    buffer_load_dwordx4 v8, s[60:63], s85 offen sc1 lds
    v_mfma_f32_16x16x32_bf16 v[180:183], v[60:63], v[32:35], v[180:183]
    s_add_u32 m0, s74, 5120
    v_mfma_f32_16x16x32_bf16 v[184:187], v[64:67], v[32:35], v[184:187]
    s_waitcnt vmcnt(5)
    buffer_load_dwordx4 v7, s[48:51], s75 offen lds
    v_mfma_f32_16x16x32_bf16 v[188:191], v[68:71], v[32:35], v[188:191]
    s_waitcnt vmcnt(5)
    buffer_load_dwordx4 v[32:35], v5, s[60:63], s76 offen sc1
    v_mfma_f32_16x16x32_bf16 v[192:195], v[52:55], v[36:39], v[192:195]
    s_add_u32 s75, s75, 9216
    s_add_u32 m0, s74, 6144
    v_mfma_f32_16x16x32_bf16 v[196:199], v[56:59], v[36:39], v[196:199]
    s_waitcnt vmcnt(5)
    buffer_load_dwordx4 v7, s[48:51], s75 offen lds
    v_mfma_f32_16x16x32_bf16 v[200:203], v[60:63], v[36:39], v[200:203]
    s_add_u32 s75, s75, 9216
    s_add_u32 m0, s74, 7168
    v_mfma_f32_16x16x32_bf16 v[204:207], v[64:67], v[36:39], v[204:207]
    s_waitcnt vmcnt(5)
    buffer_load_dwordx4 v[36:39], v6, s[60:63], s76 offen offset:0 sc1
    v_mfma_f32_16x16x32_bf16 v[208:211], v[52:55], v[40:43], v[208:211]
    s_waitcnt vmcnt(5)
    buffer_load_dwordx4 v7, s[48:51], s75 offen lds
    v_mfma_f32_16x16x32_bf16 v[212:215], v[56:59], v[40:43], v[212:215]
    s_add_u32 s75, s75, 9216
    s_add_u32 m0, s74, 8192
    v_mfma_f32_16x16x32_bf16 v[216:219], v[60:63], v[40:43], v[216:219]
    s_waitcnt vmcnt(5)
    buffer_load_dwordx4 v7, s[48:51], s75 offen lds
    v_mfma_f32_16x16x32_bf16 v[220:223], v[64:67], v[40:43], v[220:223]
    s_waitcnt vmcnt(5)
    buffer_load_dwordx4 v[40:43], v6, s[60:63], s76 offen offset:1024 sc1
    v_mfma_f32_16x16x32_bf16 v[224:227], v[52:55], v[44:47], v[224:227]
    v_mfma_f32_16x16x32_bf16 v[228:231], v[56:59], v[44:47], v[228:231]
    v_mfma_f32_16x16x32_bf16 v[232:235], v[60:63], v[44:47], v[232:235]
    v_mfma_f32_16x16x32_bf16 v[236:239], v[64:67], v[44:47], v[236:239]
    s_waitcnt vmcnt(5)
    buffer_load_dwordx4 v[44:47], v6, s[60:63], s76 offen offset:2048 sc1
    v_mfma_f32_16x16x32_bf16 v[240:243], v[52:55], v[48:51], v[240:243]
    v_mfma_f32_16x16x32_bf16 v[244:247], v[56:59], v[48:51], v[244:247]
    v_mfma_f32_16x16x32_bf16 v[248:251], v[60:63], v[48:51], v[248:251]
    v_mfma_f32_16x16x32_bf16 v[252:255], v[64:67], v[48:51], v[252:255]
    s_waitcnt vmcnt(5)
    buffer_load_dwordx4 v[48:51], v6, s[60:63], s76 offen offset:3072 sc1
    v_mfma_f32_16x16x32_bf16 v[92:95], v[72:75], v[16:19], v[92:95]
    s_add_u32 s76, s71, s8
    v_mfma_f32_16x16x32_bf16 v[96:99], v[76:79], v[16:19], v[96:99]
    ds_read_b64_tr_b16 v[52:53], v9 offset:0
    v_mfma_f32_16x16x32_bf16 v[100:103], v[80:83], v[16:19], v[100:103]
    ds_read_b64_tr_b16 v[54:55], v9 offset:2048
    v_mfma_f32_16x16x32_bf16 v[104:107], v[84:87], v[16:19], v[104:107]
    ds_read_b64_tr_b16 v[56:57], v10 offset:0
    v_mfma_f32_16x16x32_bf16 v[108:111], v[88:91], v[16:19], v[108:111]
    s_waitcnt vmcnt(5)
    buffer_load_dwordx4 v[16:19], v4, s[60:63], s76 offen offset:0 sc1
    v_mfma_f32_16x16x32_bf16 v[112:115], v[72:75], v[20:23], v[112:115]
    ds_read_b64_tr_b16 v[58:59], v10 offset:2048
    v_mfma_f32_16x16x32_bf16 v[116:119], v[76:79], v[20:23], v[116:119]
    ds_read_b64_tr_b16 v[60:61], v11 offset:0
    v_mfma_f32_16x16x32_bf16 v[120:123], v[80:83], v[20:23], v[120:123]
    ds_read_b64_tr_b16 v[62:63], v11 offset:2048
    v_mfma_f32_16x16x32_bf16 v[124:127], v[84:87], v[20:23], v[124:127]
    ds_read_b64_tr_b16 v[64:65], v12 offset:0
    v_mfma_f32_16x16x32_bf16 v[128:131], v[88:91], v[20:23], v[128:131]
    s_waitcnt vmcnt(5)
    buffer_load_dwordx4 v[20:23], v4, s[60:63], s76 offen offset:1024 sc1
    v_mfma_f32_16x16x32_bf16 v[132:135], v[72:75], v[24:27], v[132:135]
    ds_read_b64_tr_b16 v[66:67], v12 offset:2048
    v_mfma_f32_16x16x32_bf16 v[136:139], v[76:79], v[24:27], v[136:139]
    ds_read_b64_tr_b16 v[68:69], v13 offset:4096
    v_mfma_f32_16x16x32_bf16 v[140:143], v[80:83], v[24:27], v[140:143]
    ds_read_b64_tr_b16 v[70:71], v13 offset:4608
    v_mfma_f32_16x16x32_bf16 v[144:147], v[84:87], v[24:27], v[144:147]
    v_mfma_f32_16x16x32_bf16 v[148:151], v[88:91], v[24:27], v[148:151]
    s_waitcnt vmcnt(5)
    buffer_load_dwordx4 v[24:27], v4, s[60:63], s76 offen offset:2048 sc1
    v_mfma_f32_16x16x32_bf16 v[152:155], v[72:75], v[28:31], v[152:155]
    v_mfma_f32_16x16x32_bf16 v[156:159], v[76:79], v[28:31], v[156:159]
    v_mfma_f32_16x16x32_bf16 v[160:163], v[80:83], v[28:31], v[160:163]
    v_mfma_f32_16x16x32_bf16 v[164:167], v[84:87], v[28:31], v[164:167]
    s_waitcnt lgkmcnt(0)
    s_lshl2_add_u32 s75, s10, s72
    s_add_u32 m0, s74, 4096
    v_mfma_f32_16x16x32_bf16 v[168:171], v[88:91], v[28:31], v[168:171]
    s_waitcnt vmcnt(5)
    buffer_load_dwordx4 v[28:31], v4, s[60:63], s76 offen offset:3072 sc1
    v_mfma_f32_16x16x32_bf16 v[172:175], v[72:75], v[32:35], v[172:175]
    s_lshr_b32 s85, s75, 12
    s_mul_hi_u32 s85, s85, s97
    s_lshl_b32 s85, s85, 10
    v_mfma_f32_16x16x32_bf16 v[176:179], v[76:79], v[32:35], v[176:179]
    s_waitcnt vmcnt(5)
    buffer_load_dwordx4 v8, s[60:63], s85 offen sc1 lds
    v_mfma_f32_16x16x32_bf16 v[180:183], v[80:83], v[32:35], v[180:183]
    s_add_u32 m0, s74, 0
    v_mfma_f32_16x16x32_bf16 v[184:187], v[84:87], v[32:35], v[184:187]
    s_waitcnt vmcnt(5)
    buffer_load_dwordx4 v7, s[48:51], s75 offen lds
    v_mfma_f32_16x16x32_bf16 v[188:191], v[88:91], v[32:35], v[188:191]
    s_waitcnt vmcnt(5)
    buffer_load_dwordx4 v[32:35], v5, s[60:63], s76 offen sc1
    v_mfma_f32_16x16x32_bf16 v[192:195], v[72:75], v[36:39], v[192:195]
    s_add_u32 s75, s75, 9216
    s_add_u32 m0, s74, 1024
    v_mfma_f32_16x16x32_bf16 v[196:199], v[76:79], v[36:39], v[196:199]
    s_waitcnt vmcnt(5)
    buffer_load_dwordx4 v7, s[48:51], s75 offen lds
    v_mfma_f32_16x16x32_bf16 v[200:203], v[80:83], v[36:39], v[200:203]
    s_add_u32 s75, s75, 9216
    s_add_u32 m0, s74, 2048
    v_mfma_f32_16x16x32_bf16 v[204:207], v[84:87], v[36:39], v[204:207]
    s_waitcnt vmcnt(5)
    buffer_load_dwordx4 v[36:39], v6, s[60:63], s76 offen offset:0 sc1
    v_mfma_f32_16x16x32_bf16 v[208:211], v[72:75], v[40:43], v[208:211]
    s_waitcnt vmcnt(5)
    buffer_load_dwordx4 v7, s[48:51], s75 offen lds
    v_mfma_f32_16x16x32_bf16 v[212:215], v[76:79], v[40:43], v[212:215]
    s_add_u32 s75, s75, 9216
    s_add_u32 m0, s74, 3072
    v_mfma_f32_16x16x32_bf16 v[216:219], v[80:83], v[40:43], v[216:219]
    s_waitcnt vmcnt(5)
    buffer_load_dwordx4 v7, s[48:51], s75 offen lds
    v_mfma_f32_16x16x32_bf16 v[220:223], v[84:87], v[40:43], v[220:223]
    s_waitcnt vmcnt(5)
    buffer_load_dwordx4 v[40:43], v6, s[60:63], s76 offen offset:1024 sc1
    v_mfma_f32_16x16x32_bf16 v[224:227], v[72:75], v[44:47], v[224:227]
    v_mfma_f32_16x16x32_bf16 v[228:231], v[76:79], v[44:47], v[228:231]
    v_mfma_f32_16x16x32_bf16 v[232:235], v[80:83], v[44:47], v[232:235]
    v_mfma_f32_16x16x32_bf16 v[236:239], v[84:87], v[44:47], v[236:239]
    s_waitcnt vmcnt(5)
    buffer_load_dwordx4 v[44:47], v6, s[60:63], s76 offen offset:2048 sc1
    v_mfma_f32_16x16x32_bf16 v[240:243], v[72:75], v[48:51], v[240:243]
    v_mfma_f32_16x16x32_bf16 v[244:247], v[76:79], v[48:51], v[244:247]
    v_mfma_f32_16x16x32_bf16 v[248:251], v[80:83], v[48:51], v[248:251]
    v_mfma_f32_16x16x32_bf16 v[252:255], v[84:87], v[48:51], v[252:255]
    s_waitcnt vmcnt(5)
    buffer_load_dwordx4 v[48:51], v6, s[60:63], s76 offen offset:3072 sc1
    v_mfma_f32_16x16x32_bf16 v[92:95], v[52:55], v[16:19], v[92:95]
    s_add_u32 s76, s71, s9
    v_mfma_f32_16x16x32_bf16 v[96:99], v[56:59], v[16:19], v[96:99]
    ds_read_b64_tr_b16 v[72:73], v9 offset:5120
    v_mfma_f32_16x16x32_bf16 v[100:103], v[60:63], v[16:19], v[100:103]
    ds_read_b64_tr_b16 v[74:75], v9 offset:7168
    v_mfma_f32_16x16x32_bf16 v[104:107], v[64:67], v[16:19], v[104:107]
    ds_read_b64_tr_b16 v[76:77], v10 offset:5120
    v_mfma_f32_16x16x32_bf16 v[108:111], v[68:71], v[16:19], v[108:111]
    s_waitcnt vmcnt(5)
    buffer_load_dwordx4 v[16:19], v4, s[60:63], s76 offen offset:0 sc1
    v_mfma_f32_16x16x32_bf16 v[112:115], v[52:55], v[20:23], v[112:115]
    ds_read_b64_tr_b16 v[78:79], v10 offset:7168
    v_mfma_f32_16x16x32_bf16 v[116:119], v[56:59], v[20:23], v[116:119]
    ds_read_b64_tr_b16 v[80:81], v11 offset:5120
    v_mfma_f32_16x16x32_bf16 v[120:123], v[60:63], v[20:23], v[120:123]
    ds_read_b64_tr_b16 v[82:83], v11 offset:7168
    v_mfma_f32_16x16x32_bf16 v[124:127], v[64:67], v[20:23], v[124:127]
    ds_read_b64_tr_b16 v[84:85], v12 offset:5120
    v_mfma_f32_16x16x32_bf16 v[128:131], v[68:71], v[20:23], v[128:131]
    s_waitcnt vmcnt(5)
    buffer_load_dwordx4 v[20:23], v4, s[60:63], s76 offen offset:1024 sc1
    v_mfma_f32_16x16x32_bf16 v[132:135], v[52:55], v[24:27], v[132:135]
    ds_read_b64_tr_b16 v[86:87], v12 offset:7168
    v_mfma_f32_16x16x32_bf16 v[136:139], v[56:59], v[24:27], v[136:139]
    ds_read_b64_tr_b16 v[88:89], v13 offset:9216
    v_mfma_f32_16x16x32_bf16 v[140:143], v[60:63], v[24:27], v[140:143]
    ds_read_b64_tr_b16 v[90:91], v13 offset:9728
    v_mfma_f32_16x16x32_bf16 v[144:147], v[64:67], v[24:27], v[144:147]
    v_mfma_f32_16x16x32_bf16 v[148:151], v[68:71], v[24:27], v[148:151]
    s_waitcnt vmcnt(5)
    buffer_load_dwordx4 v[24:27], v4, s[60:63], s76 offen offset:2048 sc1
    v_mfma_f32_16x16x32_bf16 v[152:155], v[52:55], v[28:31], v[152:155]
    v_mfma_f32_16x16x32_bf16 v[156:159], v[56:59], v[28:31], v[156:159]
    v_mfma_f32_16x16x32_bf16 v[160:163], v[60:63], v[28:31], v[160:163]
    v_mfma_f32_16x16x32_bf16 v[164:167], v[64:67], v[28:31], v[164:167]
    s_waitcnt lgkmcnt(0)
    s_lshl2_add_u32 s75, s11, s72
    s_add_u32 m0, s74, 9216
    v_mfma_f32_16x16x32_bf16 v[168:171], v[68:71], v[28:31], v[168:171]
    s_waitcnt vmcnt(5)
    buffer_load_dwordx4 v[28:31], v4, s[60:63], s76 offen offset:3072 sc1
    v_mfma_f32_16x16x32_bf16 v[172:175], v[52:55], v[32:35], v[172:175]
    s_lshr_b32 s85, s75, 12
    s_mul_hi_u32 s85, s85, s97
    s_lshl_b32 s85, s85, 10
    v_mfma_f32_16x16x32_bf16 v[176:179], v[56:59], v[32:35], v[176:179]
    s_waitcnt vmcnt(5)
    buffer_load_dwordx4 v8, s[60:63], s85 offen sc1 lds
    v_mfma_f32_16x16x32_bf16 v[180:183], v[60:63], v[32:35], v[180:183]
    s_add_u32 m0, s74, 5120
    v_mfma_f32_16x16x32_bf16 v[184:187], v[64:67], v[32:35], v[184:187]
    s_waitcnt vmcnt(5)
    buffer_load_dwordx4 v7, s[48:51], s75 offen lds
    v_mfma_f32_16x16x32_bf16 v[188:191], v[68:71], v[32:35], v[188:191]
    s_waitcnt vmcnt(5)
    buffer_load_dwordx4 v[32:35], v5, s[60:63], s76 offen sc1
    v_mfma_f32_16x16x32_bf16 v[192:195], v[52:55], v[36:39], v[192:195]
    s_add_u32 s75, s75, 9216
    s_add_u32 m0, s74, 6144
    v_mfma_f32_16x16x32_bf16 v[196:199], v[56:59], v[36:39], v[196:199]
    s_waitcnt vmcnt(5)
    buffer_load_dwordx4 v7, s[48:51], s75 offen lds
    v_mfma_f32_16x16x32_bf16 v[200:203], v[60:63], v[36:39], v[200:203]
    s_add_u32 s75, s75, 9216
    s_add_u32 m0, s74, 7168
    v_mfma_f32_16x16x32_bf16 v[204:207], v[64:67], v[36:39], v[204:207]
    s_waitcnt vmcnt(5)
    buffer_load_dwordx4 v[36:39], v6, s[60:63], s76 offen offset:0 sc1
    v_mfma_f32_16x16x32_bf16 v[208:211], v[52:55], v[40:43], v[208:211]
    s_waitcnt vmcnt(5)
    buffer_load_dwordx4 v7, s[48:51], s75 offen lds
    v_mfma_f32_16x16x32_bf16 v[212:215], v[56:59], v[40:43], v[212:215]
    s_add_u32 s75, s75, 9216
    s_add_u32 m0, s74, 8192
    v_mfma_f32_16x16x32_bf16 v[216:219], v[60:63], v[40:43], v[216:219]
    s_waitcnt vmcnt(5)
    buffer_load_dwordx4 v7, s[48:51], s75 offen lds
    v_mfma_f32_16x16x32_bf16 v[220:223], v[64:67], v[40:43], v[220:223]
    s_waitcnt vmcnt(5)
    buffer_load_dwordx4 v[40:43], v6, s[60:63], s76 offen offset:1024 sc1
    v_mfma_f32_16x16x32_bf16 v[224:227], v[52:55], v[44:47], v[224:227]
    v_mfma_f32_16x16x32_bf16 v[228:231], v[56:59], v[44:47], v[228:231]
    v_mfma_f32_16x16x32_bf16 v[232:235], v[60:63], v[44:47], v[232:235]
    v_mfma_f32_16x16x32_bf16 v[236:239], v[64:67], v[44:47], v[236:239]
    s_waitcnt vmcnt(5)
    buffer_load_dwordx4 v[44:47], v6, s[60:63], s76 offen offset:2048 sc1
    v_mfma_f32_16x16x32_bf16 v[240:243], v[52:55], v[48:51], v[240:243]
    v_mfma_f32_16x16x32_bf16 v[244:247], v[56:59], v[48:51], v[244:247]
    v_mfma_f32_16x16x32_bf16 v[248:251], v[60:63], v[48:51], v[248:251]
    v_mfma_f32_16x16x32_bf16 v[252:255], v[64:67], v[48:51], v[252:255]
    s_waitcnt vmcnt(5)
    buffer_load_dwordx4 v[48:51], v6, s[60:63], s76 offen offset:3072 sc1
    v_mfma_f32_16x16x32_bf16 v[92:95], v[72:75], v[16:19], v[92:95]
    s_add_u32 s76, s71, s10
    v_mfma_f32_16x16x32_bf16 v[96:99], v[76:79], v[16:19], v[96:99]
    ds_read_b64_tr_b16 v[52:53], v9 offset:0
    v_mfma_f32_16x16x32_bf16 v[100:103], v[80:83], v[16:19], v[100:103]
    ds_read_b64_tr_b16 v[54:55], v9 offset:2048
    v_mfma_f32_16x16x32_bf16 v[104:107], v[84:87], v[16:19], v[104:107]
    ds_read_b64_tr_b16 v[56:57], v10 offset:0
    v_mfma_f32_16x16x32_bf16 v[108:111], v[88:91], v[16:19], v[108:111]
    s_waitcnt vmcnt(5)
    buffer_load_dwordx4 v[16:19], v4, s[60:63], s76 offen offset:0 sc1
    v_mfma_f32_16x16x32_bf16 v[112:115], v[72:75], v[20:23], v[112:115]
    ds_read_b64_tr_b16 v[58:59], v10 offset:2048
    v_mfma_f32_16x16x32_bf16 v[116:119], v[76:79], v[20:23], v[116:119]
    ds_read_b64_tr_b16 v[60:61], v11 offset:0
    v_mfma_f32_16x16x32_bf16 v[120:123], v[80:83], v[20:23], v[120:123]
    ds_read_b64_tr_b16 v[62:63], v11 offset:2048
    v_mfma_f32_16x16x32_bf16 v[124:127], v[84:87], v[20:23], v[124:127]
    ds_read_b64_tr_b16 v[64:65], v12 offset:0
    v_mfma_f32_16x16x32_bf16 v[128:131], v[88:91], v[20:23], v[128:131]
    s_waitcnt vmcnt(5)
    buffer_load_dwordx4 v[20:23], v4, s[60:63], s76 offen offset:1024 sc1
    v_mfma_f32_16x16x32_bf16 v[132:135], v[72:75], v[24:27], v[132:135]
    ds_read_b64_tr_b16 v[66:67], v12 offset:2048
    v_mfma_f32_16x16x32_bf16 v[136:139], v[76:79], v[24:27], v[136:139]
    ds_read_b64_tr_b16 v[68:69], v13 offset:4096
    v_mfma_f32_16x16x32_bf16 v[140:143], v[80:83], v[24:27], v[140:143]
    ds_read_b64_tr_b16 v[70:71], v13 offset:4608
    v_mfma_f32_16x16x32_bf16 v[144:147], v[84:87], v[24:27], v[144:147]
    v_mfma_f32_16x16x32_bf16 v[148:151], v[88:91], v[24:27], v[148:151]
    s_waitcnt vmcnt(5)
    buffer_load_dwordx4 v[24:27], v4, s[60:63], s76 offen offset:2048 sc1
    v_mfma_f32_16x16x32_bf16 v[152:155], v[72:75], v[28:31], v[152:155]
    v_mfma_f32_16x16x32_bf16 v[156:159], v[76:79], v[28:31], v[156:159]
    v_mfma_f32_16x16x32_bf16 v[160:163], v[80:83], v[28:31], v[160:163]
    v_mfma_f32_16x16x32_bf16 v[164:167], v[84:87], v[28:31], v[164:167]
    s_waitcnt lgkmcnt(0)
    s_lshl2_add_u32 s75, s12, s72
    s_add_u32 m0, s74, 4096
    v_mfma_f32_16x16x32_bf16 v[168:171], v[88:91], v[28:31], v[168:171]
    s_waitcnt vmcnt(5)
    buffer_load_dwordx4 v[28:31], v4, s[60:63], s76 offen offset:3072 sc1
    v_mfma_f32_16x16x32_bf16 v[172:175], v[72:75], v[32:35], v[172:175]
    s_lshr_b32 s85, s75, 12
    s_mul_hi_u32 s85, s85, s97
    s_lshl_b32 s85, s85, 10
    v_mfma_f32_16x16x32_bf16 v[176:179], v[76:79], v[32:35], v[176:179]
    s_waitcnt vmcnt(5)
    buffer_load_dwordx4 v8, s[60:63], s85 offen sc1 lds
    v_mfma_f32_16x16x32_bf16 v[180:183], v[80:83], v[32:35], v[180:183]
    s_add_u32 m0, s74, 0
    v_mfma_f32_16x16x32_bf16 v[184:187], v[84:87], v[32:35], v[184:187]
    s_waitcnt vmcnt(5)
    buffer_load_dwordx4 v7, s[48:51], s75 offen lds
    v_mfma_f32_16x16x32_bf16 v[188:191], v[88:91], v[32:35], v[188:191]
    s_waitcnt vmcnt(5)
    buffer_load_dwordx4 v[32:35], v5, s[60:63], s76 offen sc1
    v_mfma_f32_16x16x32_bf16 v[192:195], v[72:75], v[36:39], v[192:195]
    s_add_u32 s75, s75, 9216
    s_add_u32 m0, s74, 1024
    v_mfma_f32_16x16x32_bf16 v[196:199], v[76:79], v[36:39], v[196:199]
    s_waitcnt vmcnt(5)
    buffer_load_dwordx4 v7, s[48:51], s75 offen lds
    v_mfma_f32_16x16x32_bf16 v[200:203], v[80:83], v[36:39], v[200:203]
    s_add_u32 s75, s75, 9216
    s_add_u32 m0, s74, 2048
    v_mfma_f32_16x16x32_bf16 v[204:207], v[84:87], v[36:39], v[204:207]
    s_waitcnt vmcnt(5)
    buffer_load_dwordx4 v[36:39], v6, s[60:63], s76 offen offset:0 sc1
    v_mfma_f32_16x16x32_bf16 v[208:211], v[72:75], v[40:43], v[208:211]
    s_waitcnt vmcnt(5)
    buffer_load_dwordx4 v7, s[48:51], s75 offen lds
    v_mfma_f32_16x16x32_bf16 v[212:215], v[76:79], v[40:43], v[212:215]
    s_add_u32 s75, s75, 9216
    s_add_u32 m0, s74, 3072
    v_mfma_f32_16x16x32_bf16 v[216:219], v[80:83], v[40:43], v[216:219]
    s_waitcnt vmcnt(5)
    buffer_load_dwordx4 v7, s[48:51], s75 offen lds
    v_mfma_f32_16x16x32_bf16 v[220:223], v[84:87], v[40:43], v[220:223]
    s_waitcnt vmcnt(5)
    buffer_load_dwordx4 v[40:43], v6, s[60:63], s76 offen offset:1024 sc1
    v_mfma_f32_16x16x32_bf16 v[224:227], v[72:75], v[44:47], v[224:227]
    v_mfma_f32_16x16x32_bf16 v[228:231], v[76:79], v[44:47], v[228:231]
    v_mfma_f32_16x16x32_bf16 v[232:235], v[80:83], v[44:47], v[232:235]
    v_mfma_f32_16x16x32_bf16 v[236:239], v[84:87], v[44:47], v[236:239]
    s_waitcnt vmcnt(5)
    buffer_load_dwordx4 v[44:47], v6, s[60:63], s76 offen offset:2048 sc1
    v_mfma_f32_16x16x32_bf16 v[240:243], v[72:75], v[48:51], v[240:243]
    v_mfma_f32_16x16x32_bf16 v[244:247], v[76:79], v[48:51], v[244:247]
    v_mfma_f32_16x16x32_bf16 v[248:251], v[80:83], v[48:51], v[248:251]
    v_mfma_f32_16x16x32_bf16 v[252:255], v[84:87], v[48:51], v[252:255]
    s_waitcnt vmcnt(5)
    buffer_load_dwordx4 v[48:51], v6, s[60:63], s76 offen offset:3072 sc1
    v_mfma_f32_16x16x32_bf16 v[92:95], v[52:55], v[16:19], v[92:95]
    s_add_u32 s76, s71, s11
    v_mfma_f32_16x16x32_bf16 v[96:99], v[56:59], v[16:19], v[96:99]
    ds_read_b64_tr_b16 v[72:73], v9 offset:5120
    v_mfma_f32_16x16x32_bf16 v[100:103], v[60:63], v[16:19], v[100:103]
    ds_read_b64_tr_b16 v[74:75], v9 offset:7168
    v_mfma_f32_16x16x32_bf16 v[104:107], v[64:67], v[16:19], v[104:107]
    ds_read_b64_tr_b16 v[76:77], v10 offset:5120
    v_mfma_f32_16x16x32_bf16 v[108:111], v[68:71], v[16:19], v[108:111]
    s_waitcnt vmcnt(5)
    buffer_load_dwordx4 v[16:19], v4, s[60:63], s76 offen offset:0 sc1
    v_mfma_f32_16x16x32_bf16 v[112:115], v[52:55], v[20:23], v[112:115]
    ds_read_b64_tr_b16 v[78:79], v10 offset:7168
    v_mfma_f32_16x16x32_bf16 v[116:119], v[56:59], v[20:23], v[116:119]
    ds_read_b64_tr_b16 v[80:81], v11 offset:5120
    v_mfma_f32_16x16x32_bf16 v[120:123], v[60:63], v[20:23], v[120:123]
    ds_read_b64_tr_b16 v[82:83], v11 offset:7168
    v_mfma_f32_16x16x32_bf16 v[124:127], v[64:67], v[20:23], v[124:127]
    ds_read_b64_tr_b16 v[84:85], v12 offset:5120
    v_mfma_f32_16x16x32_bf16 v[128:131], v[68:71], v[20:23], v[128:131]
    s_waitcnt vmcnt(5)
    buffer_load_dwordx4 v[20:23], v4, s[60:63], s76 offen offset:1024 sc1
    v_mfma_f32_16x16x32_bf16 v[132:135], v[52:55], v[24:27], v[132:135]
    ds_read_b64_tr_b16 v[86:87], v12 offset:7168
    v_mfma_f32_16x16x32_bf16 v[136:139], v[56:59], v[24:27], v[136:139]
    ds_read_b64_tr_b16 v[88:89], v13 offset:9216
    v_mfma_f32_16x16x32_bf16 v[140:143], v[60:63], v[24:27], v[140:143]
    ds_read_b64_tr_b16 v[90:91], v13 offset:9728
    v_mfma_f32_16x16x32_bf16 v[144:147], v[64:67], v[24:27], v[144:147]
    v_mfma_f32_16x16x32_bf16 v[148:151], v[68:71], v[24:27], v[148:151]
    s_waitcnt vmcnt(5)
    buffer_load_dwordx4 v[24:27], v4, s[60:63], s76 offen offset:2048 sc1
    v_mfma_f32_16x16x32_bf16 v[152:155], v[52:55], v[28:31], v[152:155]
    v_mfma_f32_16x16x32_bf16 v[156:159], v[56:59], v[28:31], v[156:159]
    v_mfma_f32_16x16x32_bf16 v[160:163], v[60:63], v[28:31], v[160:163]
    v_mfma_f32_16x16x32_bf16 v[164:167], v[64:67], v[28:31], v[164:167]
    s_waitcnt lgkmcnt(0)
    s_lshl2_add_u32 s75, s13, s72
    s_add_u32 m0, s74, 9216
    v_mfma_f32_16x16x32_bf16 v[168:171], v[68:71], v[28:31], v[168:171]
    s_waitcnt vmcnt(5)
    buffer_load_dwordx4 v[28:31], v4, s[60:63], s76 offen offset:3072 sc1
    v_mfma_f32_16x16x32_bf16 v[172:175], v[52:55], v[32:35], v[172:175]
    s_lshr_b32 s85, s75, 12
    s_mul_hi_u32 s85, s85, s97
    s_lshl_b32 s85, s85, 10
    v_mfma_f32_16x16x32_bf16 v[176:179], v[56:59], v[32:35], v[176:179]
    s_waitcnt vmcnt(5)
    buffer_load_dwordx4 v8, s[60:63], s85 offen sc1 lds
    v_mfma_f32_16x16x32_bf16 v[180:183], v[60:63], v[32:35], v[180:183]
    s_add_u32 m0, s74, 5120
    v_mfma_f32_16x16x32_bf16 v[184:187], v[64:67], v[32:35], v[184:187]
    s_waitcnt vmcnt(5)
    buffer_load_dwordx4 v7, s[48:51], s75 offen lds
    v_mfma_f32_16x16x32_bf16 v[188:191], v[68:71], v[32:35], v[188:191]
    s_waitcnt vmcnt(5)
    buffer_load_dwordx4 v[32:35], v5, s[60:63], s76 offen sc1
    v_mfma_f32_16x16x32_bf16 v[192:195], v[52:55], v[36:39], v[192:195]
    s_add_u32 s75, s75, 9216
    s_add_u32 m0, s74, 6144
    v_mfma_f32_16x16x32_bf16 v[196:199], v[56:59], v[36:39], v[196:199]
    s_waitcnt vmcnt(5)
    buffer_load_dwordx4 v7, s[48:51], s75 offen lds
    v_mfma_f32_16x16x32_bf16 v[200:203], v[60:63], v[36:39], v[200:203]
    s_add_u32 s75, s75, 9216
    s_add_u32 m0, s74, 7168
    v_mfma_f32_16x16x32_bf16 v[204:207], v[64:67], v[36:39], v[204:207]
    s_waitcnt vmcnt(5)
    buffer_load_dwordx4 v[36:39], v6, s[60:63], s76 offen offset:0 sc1
    v_mfma_f32_16x16x32_bf16 v[208:211], v[52:55], v[40:43], v[208:211]
    s_waitcnt vmcnt(5)
    buffer_load_dwordx4 v7, s[48:51], s75 offen lds
    v_mfma_f32_16x16x32_bf16 v[212:215], v[56:59], v[40:43], v[212:215]
    s_add_u32 s75, s75, 9216
    s_add_u32 m0, s74, 8192
    v_mfma_f32_16x16x32_bf16 v[216:219], v[60:63], v[40:43], v[216:219]
    s_waitcnt vmcnt(5)
    buffer_load_dwordx4 v7, s[48:51], s75 offen lds
    v_mfma_f32_16x16x32_bf16 v[220:223], v[64:67], v[40:43], v[220:223]
    s_waitcnt vmcnt(5)
    buffer_load_dwordx4 v[40:43], v6, s[60:63], s76 offen offset:1024 sc1
    v_mfma_f32_16x16x32_bf16 v[224:227], v[52:55], v[44:47], v[224:227]
    v_mfma_f32_16x16x32_bf16 v[228:231], v[56:59], v[44:47], v[228:231]
    v_mfma_f32_16x16x32_bf16 v[232:235], v[60:63], v[44:47], v[232:235]
    v_mfma_f32_16x16x32_bf16 v[236:239], v[64:67], v[44:47], v[236:239]
    s_waitcnt vmcnt(5)
    buffer_load_dwordx4 v[44:47], v6, s[60:63], s76 offen offset:2048 sc1
    v_mfma_f32_16x16x32_bf16 v[240:243], v[52:55], v[48:51], v[240:243]
    v_mfma_f32_16x16x32_bf16 v[244:247], v[56:59], v[48:51], v[244:247]
    v_mfma_f32_16x16x32_bf16 v[248:251], v[60:63], v[48:51], v[248:251]
    v_mfma_f32_16x16x32_bf16 v[252:255], v[64:67], v[48:51], v[252:255]
    s_waitcnt vmcnt(5)
    buffer_load_dwordx4 v[48:51], v6, s[60:63], s76 offen offset:3072 sc1
    v_mfma_f32_16x16x32_bf16 v[92:95], v[72:75], v[16:19], v[92:95]
    s_add_u32 s76, s71, s12
    v_mfma_f32_16x16x32_bf16 v[96:99], v[76:79], v[16:19], v[96:99]
    ds_read_b64_tr_b16 v[52:53], v9 offset:0
    v_mfma_f32_16x16x32_bf16 v[100:103], v[80:83], v[16:19], v[100:103]
    ds_read_b64_tr_b16 v[54:55], v9 offset:2048
    v_mfma_f32_16x16x32_bf16 v[104:107], v[84:87], v[16:19], v[104:107]
    ds_read_b64_tr_b16 v[56:57], v10 offset:0
    v_mfma_f32_16x16x32_bf16 v[108:111], v[88:91], v[16:19], v[108:111]
    s_waitcnt vmcnt(5)
    buffer_load_dwordx4 v[16:19], v4, s[60:63], s76 offen offset:0 sc1
    v_mfma_f32_16x16x32_bf16 v[112:115], v[72:75], v[20:23], v[112:115]
    ds_read_b64_tr_b16 v[58:59], v10 offset:2048
    v_mfma_f32_16x16x32_bf16 v[116:119], v[76:79], v[20:23], v[116:119]
    ds_read_b64_tr_b16 v[60:61], v11 offset:0
    v_mfma_f32_16x16x32_bf16 v[120:123], v[80:83], v[20:23], v[120:123]
    ds_read_b64_tr_b16 v[62:63], v11 offset:2048
    v_mfma_f32_16x16x32_bf16 v[124:127], v[84:87], v[20:23], v[124:127]
    ds_read_b64_tr_b16 v[64:65], v12 offset:0
    v_mfma_f32_16x16x32_bf16 v[128:131], v[88:91], v[20:23], v[128:131]
    s_waitcnt vmcnt(5)
    buffer_load_dwordx4 v[20:23], v4, s[60:63], s76 offen offset:1024 sc1
    v_mfma_f32_16x16x32_bf16 v[132:135], v[72:75], v[24:27], v[132:135]
    ds_read_b64_tr_b16 v[66:67], v12 offset:2048
    v_mfma_f32_16x16x32_bf16 v[136:139], v[76:79], v[24:27], v[136:139]
    ds_read_b64_tr_b16 v[68:69], v13 offset:4096
    v_mfma_f32_16x16x32_bf16 v[140:143], v[80:83], v[24:27], v[140:143]
    ds_read_b64_tr_b16 v[70:71], v13 offset:4608
    v_mfma_f32_16x16x32_bf16 v[144:147], v[84:87], v[24:27], v[144:147]
    v_mfma_f32_16x16x32_bf16 v[148:151], v[88:91], v[24:27], v[148:151]
    s_waitcnt vmcnt(5)
    buffer_load_dwordx4 v[24:27], v4, s[60:63], s76 offen offset:2048 sc1
    v_mfma_f32_16x16x32_bf16 v[152:155], v[72:75], v[28:31], v[152:155]
    v_mfma_f32_16x16x32_bf16 v[156:159], v[76:79], v[28:31], v[156:159]
    v_mfma_f32_16x16x32_bf16 v[160:163], v[80:83], v[28:31], v[160:163]
    v_mfma_f32_16x16x32_bf16 v[164:167], v[84:87], v[28:31], v[164:167]
    s_waitcnt lgkmcnt(0)
    s_lshl2_add_u32 s75, s6, s72
    s_add_u32 s75, s75, 147456
    v_mfma_f32_16x16x32_bf16 v[168:171], v[88:91], v[28:31], v[168:171]
    s_waitcnt vmcnt(5)
    buffer_load_dwordx4 v[28:31], v4, s[60:63], s76 offen offset:3072 sc1
    v_mfma_f32_16x16x32_bf16 v[172:175], v[72:75], v[32:35], v[172:175]
    s_cmp_eq_u32 s73, 3
    s_cselect_b32 s75, 1073741824, s75
    s_add_u32 m0, s74, 4096
    s_lshr_b32 s85, s75, 12
    s_mul_hi_u32 s85, s85, s97
    s_lshl_b32 s85, s85, 10
    v_mfma_f32_16x16x32_bf16 v[176:179], v[76:79], v[32:35], v[176:179]
    s_waitcnt vmcnt(5)
    buffer_load_dwordx4 v8, s[60:63], s85 offen sc1 lds
    v_mfma_f32_16x16x32_bf16 v[180:183], v[80:83], v[32:35], v[180:183]
    s_add_u32 m0, s74, 0
    v_mfma_f32_16x16x32_bf16 v[184:187], v[84:87], v[32:35], v[184:187]
    s_waitcnt vmcnt(5)
    buffer_load_dwordx4 v7, s[48:51], s75 offen lds
    v_mfma_f32_16x16x32_bf16 v[188:191], v[88:91], v[32:35], v[188:191]
    s_waitcnt vmcnt(5)
    buffer_load_dwordx4 v[32:35], v5, s[60:63], s76 offen sc1
    v_mfma_f32_16x16x32_bf16 v[192:195], v[72:75], v[36:39], v[192:195]
    s_add_u32 s75, s75, 9216
    s_add_u32 m0, s74, 1024
    v_mfma_f32_16x16x32_bf16 v[196:199], v[76:79], v[36:39], v[196:199]
    s_waitcnt vmcnt(5)
    buffer_load_dwordx4 v7, s[48:51], s75 offen lds
    v_mfma_f32_16x16x32_bf16 v[200:203], v[80:83], v[36:39], v[200:203]
    s_add_u32 s75, s75, 9216
    s_add_u32 m0, s74, 2048
    v_mfma_f32_16x16x32_bf16 v[204:207], v[84:87], v[36:39], v[204:207]
    s_waitcnt vmcnt(5)
    buffer_load_dwordx4 v[36:39], v6, s[60:63], s76 offen offset:0 sc1
    v_mfma_f32_16x16x32_bf16 v[208:211], v[72:75], v[40:43], v[208:211]
    s_waitcnt vmcnt(5)
    buffer_load_dwordx4 v7, s[48:51], s75 offen lds
    v_mfma_f32_16x16x32_bf16 v[212:215], v[76:79], v[40:43], v[212:215]
    s_add_u32 s75, s75, 9216
    s_add_u32 m0, s74, 3072
    v_mfma_f32_16x16x32_bf16 v[216:219], v[80:83], v[40:43], v[216:219]
    s_waitcnt vmcnt(5)
    buffer_load_dwordx4 v7, s[48:51], s75 offen lds
    v_mfma_f32_16x16x32_bf16 v[220:223], v[84:87], v[40:43], v[220:223]
    s_waitcnt vmcnt(5)
    buffer_load_dwordx4 v[40:43], v6, s[60:63], s76 offen offset:1024 sc1
    v_mfma_f32_16x16x32_bf16 v[224:227], v[72:75], v[44:47], v[224:227]
    v_mfma_f32_16x16x32_bf16 v[228:231], v[76:79], v[44:47], v[228:231]
    v_mfma_f32_16x16x32_bf16 v[232:235], v[80:83], v[44:47], v[232:235]
    v_mfma_f32_16x16x32_bf16 v[236:239], v[84:87], v[44:47], v[236:239]
    s_waitcnt vmcnt(5)
    buffer_load_dwordx4 v[44:47], v6, s[60:63], s76 offen offset:2048 sc1
    v_mfma_f32_16x16x32_bf16 v[240:243], v[72:75], v[48:51], v[240:243]
    v_mfma_f32_16x16x32_bf16 v[244:247], v[76:79], v[48:51], v[244:247]
    v_mfma_f32_16x16x32_bf16 v[248:251], v[80:83], v[48:51], v[248:251]
    v_mfma_f32_16x16x32_bf16 v[252:255], v[84:87], v[48:51], v[252:255]
    s_waitcnt vmcnt(5)
    buffer_load_dwordx4 v[48:51], v6, s[60:63], s76 offen offset:3072 sc1
    v_mfma_f32_16x16x32_bf16 v[92:95], v[52:55], v[16:19], v[92:95]
    s_add_u32 s76, s71, s13
    v_mfma_f32_16x16x32_bf16 v[96:99], v[56:59], v[16:19], v[96:99]
    ds_read_b64_tr_b16 v[72:73], v9 offset:5120
    v_mfma_f32_16x16x32_bf16 v[100:103], v[60:63], v[16:19], v[100:103]
    ds_read_b64_tr_b16 v[74:75], v9 offset:7168
    v_mfma_f32_16x16x32_bf16 v[104:107], v[64:67], v[16:19], v[104:107]
    ds_read_b64_tr_b16 v[76:77], v10 offset:5120
    v_mfma_f32_16x16x32_bf16 v[108:111], v[68:71], v[16:19], v[108:111]
    s_waitcnt vmcnt(5)
    buffer_load_dwordx4 v[16:19], v4, s[60:63], s76 offen offset:0 sc1
    v_mfma_f32_16x16x32_bf16 v[112:115], v[52:55], v[20:23], v[112:115]
    ds_read_b64_tr_b16 v[78:79], v10 offset:7168
    v_mfma_f32_16x16x32_bf16 v[116:119], v[56:59], v[20:23], v[116:119]
    ds_read_b64_tr_b16 v[80:81], v11 offset:5120
    v_mfma_f32_16x16x32_bf16 v[120:123], v[60:63], v[20:23], v[120:123]
    ds_read_b64_tr_b16 v[82:83], v11 offset:7168
    v_mfma_f32_16x16x32_bf16 v[124:127], v[64:67], v[20:23], v[124:127]
    ds_read_b64_tr_b16 v[84:85], v12 offset:5120
    v_mfma_f32_16x16x32_bf16 v[128:131], v[68:71], v[20:23], v[128:131]
    s_waitcnt vmcnt(5)
    buffer_load_dwordx4 v[20:23], v4, s[60:63], s76 offen offset:1024 sc1
    v_mfma_f32_16x16x32_bf16 v[132:135], v[52:55], v[24:27], v[132:135]
    ds_read_b64_tr_b16 v[86:87], v12 offset:7168
    v_mfma_f32_16x16x32_bf16 v[136:139], v[56:59], v[24:27], v[136:139]
    ds_read_b64_tr_b16 v[88:89], v13 offset:9216
    v_mfma_f32_16x16x32_bf16 v[140:143], v[60:63], v[24:27], v[140:143]
    ds_read_b64_tr_b16 v[90:91], v13 offset:9728
    v_mfma_f32_16x16x32_bf16 v[144:147], v[64:67], v[24:27], v[144:147]
    v_mfma_f32_16x16x32_bf16 v[148:151], v[68:71], v[24:27], v[148:151]
    s_waitcnt vmcnt(5)
    buffer_load_dwordx4 v[24:27], v4, s[60:63], s76 offen offset:2048 sc1
    v_mfma_f32_16x16x32_bf16 v[152:155], v[52:55], v[28:31], v[152:155]
    v_mfma_f32_16x16x32_bf16 v[156:159], v[56:59], v[28:31], v[156:159]
    v_mfma_f32_16x16x32_bf16 v[160:163], v[60:63], v[28:31], v[160:163]
    v_mfma_f32_16x16x32_bf16 v[164:167], v[64:67], v[28:31], v[164:167]
    s_waitcnt lgkmcnt(0)
    v_mfma_f32_16x16x32_bf16 v[168:171], v[68:71], v[28:31], v[168:171]
    s_waitcnt vmcnt(5)
    buffer_load_dwordx4 v[28:31], v4, s[60:63], s76 offen offset:3072 sc1
    v_mfma_f32_16x16x32_bf16 v[172:175], v[52:55], v[32:35], v[172:175]
    s_waitcnt vmcnt(5)
    buffer_load_dword v2, v14, s[60:63], 0 offen sc1
    v_mfma_f32_16x16x32_bf16 v[176:179], v[56:59], v[32:35], v[176:179]
    s_lshl2_add_u32 s75, s7, s72
    s_add_u32 s75, s75, 147456
    s_cmp_eq_u32 s73, 3
    s_cselect_b32 s75, 1073741824, s75
    v_mfma_f32_16x16x32_bf16 v[180:183], v[60:63], v[32:35], v[180:183]
    s_add_u32 m0, s74, 9216
    s_lshr_b32 s85, s75, 12
    s_mul_hi_u32 s85, s85, s97
    s_lshl_b32 s85, s85, 10
    v_mfma_f32_16x16x32_bf16 v[184:187], v[64:67], v[32:35], v[184:187]
    s_waitcnt vmcnt(5)
    buffer_load_dwordx4 v8, s[60:63], s85 offen sc1 lds
    v_mfma_f32_16x16x32_bf16 v[188:191], v[68:71], v[32:35], v[188:191]
    s_waitcnt vmcnt(5)
    buffer_load_dwordx4 v[32:35], v5, s[60:63], s76 offen sc1
    v_mfma_f32_16x16x32_bf16 v[192:195], v[52:55], v[36:39], v[192:195]
    s_add_u32 m0, s74, 5120
    v_mfma_f32_16x16x32_bf16 v[196:199], v[56:59], v[36:39], v[196:199]
    s_waitcnt vmcnt(5)
    buffer_load_dwordx4 v7, s[48:51], s75 offen lds
    v_mfma_f32_16x16x32_bf16 v[200:203], v[60:63], v[36:39], v[200:203]
    s_add_u32 s75, s75, 9216
    s_add_u32 m0, s74, 6144
    v_mfma_f32_16x16x32_bf16 v[204:207], v[64:67], v[36:39], v[204:207]
    s_waitcnt vmcnt(5)
    buffer_load_dwordx4 v[36:39], v6, s[60:63], s76 offen offset:0 sc1
    v_mfma_f32_16x16x32_bf16 v[208:211], v[52:55], v[40:43], v[208:211]
    s_waitcnt vmcnt(5)
    buffer_load_dwordx4 v7, s[48:51], s75 offen lds
    v_mfma_f32_16x16x32_bf16 v[212:215], v[56:59], v[40:43], v[212:215]
    s_add_u32 s75, s75, 9216
    s_add_u32 m0, s74, 7168
    v_mfma_f32_16x16x32_bf16 v[216:219], v[60:63], v[40:43], v[216:219]
    s_waitcnt vmcnt(5)
    buffer_load_dwordx4 v7, s[48:51], s75 offen lds
    v_mfma_f32_16x16x32_bf16 v[220:223], v[64:67], v[40:43], v[220:223]
    s_waitcnt vmcnt(5)
    buffer_load_dwordx4 v[40:43], v6, s[60:63], s76 offen offset:1024 sc1
    v_mfma_f32_16x16x32_bf16 v[224:227], v[52:55], v[44:47], v[224:227]
    s_add_u32 s75, s75, 9216
    s_add_u32 m0, s74, 8192
    v_mfma_f32_16x16x32_bf16 v[228:231], v[56:59], v[44:47], v[228:231]
    s_waitcnt vmcnt(5)
    buffer_load_dwordx4 v7, s[48:51], s75 offen lds
    v_mfma_f32_16x16x32_bf16 v[232:235], v[60:63], v[44:47], v[232:235]
    v_mfma_f32_16x16x32_bf16 v[236:239], v[64:67], v[44:47], v[236:239]
    s_waitcnt vmcnt(5)
    buffer_load_dwordx4 v[44:47], v6, s[60:63], s76 offen offset:2048 sc1
    v_mfma_f32_16x16x32_bf16 v[240:243], v[52:55], v[48:51], v[240:243]
    v_mfma_f32_16x16x32_bf16 v[244:247], v[56:59], v[48:51], v[244:247]
    v_mfma_f32_16x16x32_bf16 v[248:251], v[60:63], v[48:51], v[248:251]
    v_mfma_f32_16x16x32_bf16 v[252:255], v[64:67], v[48:51], v[252:255]
    s_waitcnt vmcnt(5)
    buffer_load_dwordx4 v[48:51], v6, s[60:63], s76 offen offset:3072 sc1
    v_mfma_f32_16x16x32_bf16 v[92:95], v[72:75], v[16:19], v[92:95]
    ds_read_b64_tr_b16 v[52:53], v9 offset:0
    v_mfma_f32_16x16x32_bf16 v[96:99], v[76:79], v[16:19], v[96:99]
    ds_read_b64_tr_b16 v[54:55], v9 offset:2048
    v_mfma_f32_16x16x32_bf16 v[100:103], v[80:83], v[16:19], v[100:103]
    ds_read_b64_tr_b16 v[56:57], v10 offset:0
    v_mfma_f32_16x16x32_bf16 v[104:107], v[84:87], v[16:19], v[104:107]
    ds_read_b64_tr_b16 v[58:59], v10 offset:2048
    v_mfma_f32_16x16x32_bf16 v[108:111], v[88:91], v[16:19], v[108:111]
    ds_read_b64_tr_b16 v[60:61], v11 offset:0
    v_mfma_f32_16x16x32_bf16 v[112:115], v[72:75], v[20:23], v[112:115]
    ds_read_b64_tr_b16 v[62:63], v11 offset:2048
    v_mfma_f32_16x16x32_bf16 v[116:119], v[76:79], v[20:23], v[116:119]
    ds_read_b64_tr_b16 v[64:65], v12 offset:0
    v_mfma_f32_16x16x32_bf16 v[120:123], v[80:83], v[20:23], v[120:123]
    ds_read_b64_tr_b16 v[66:67], v12 offset:2048
    v_mfma_f32_16x16x32_bf16 v[124:127], v[84:87], v[20:23], v[124:127]
    ds_read_b64_tr_b16 v[68:69], v13 offset:4096
    v_mfma_f32_16x16x32_bf16 v[128:131], v[88:91], v[20:23], v[128:131]
    ds_read_b64_tr_b16 v[70:71], v13 offset:4608
    v_mfma_f32_16x16x32_bf16 v[132:135], v[72:75], v[24:27], v[132:135]
    v_mfma_f32_16x16x32_bf16 v[136:139], v[76:79], v[24:27], v[136:139]
    v_mfma_f32_16x16x32_bf16 v[140:143], v[80:83], v[24:27], v[140:143]
    v_mfma_f32_16x16x32_bf16 v[144:147], v[84:87], v[24:27], v[144:147]
    v_mfma_f32_16x16x32_bf16 v[148:151], v[88:91], v[24:27], v[148:151]
    v_mfma_f32_16x16x32_bf16 v[152:155], v[72:75], v[28:31], v[152:155]
    v_mfma_f32_16x16x32_bf16 v[156:159], v[76:79], v[28:31], v[156:159]
    v_mfma_f32_16x16x32_bf16 v[160:163], v[80:83], v[28:31], v[160:163]
    v_mfma_f32_16x16x32_bf16 v[164:167], v[84:87], v[28:31], v[164:167]
    s_waitcnt lgkmcnt(0)
    s_lshl2_add_u32 s75, s8, s72
    s_add_u32 s75, s75, 147456
    v_mfma_f32_16x16x32_bf16 v[168:171], v[88:91], v[28:31], v[168:171]
    s_cmp_eq_u32 s73, 3
    s_cselect_b32 s75, 1073741824, s75
    s_add_u32 m0, s74, 4096
    s_lshr_b32 s85, s75, 12
    s_mul_hi_u32 s85, s85, s97
    s_lshl_b32 s85, s85, 10
    v_mfma_f32_16x16x32_bf16 v[172:175], v[72:75], v[32:35], v[172:175]
    s_waitcnt vmcnt(5)
    buffer_load_dwordx4 v8, s[60:63], s85 offen sc1 lds
    v_mfma_f32_16x16x32_bf16 v[176:179], v[76:79], v[32:35], v[176:179]
    s_add_u32 m0, s74, 0
    v_mfma_f32_16x16x32_bf16 v[180:183], v[80:83], v[32:35], v[180:183]
    s_waitcnt vmcnt(5)
    buffer_load_dwordx4 v7, s[48:51], s75 offen lds
    v_mfma_f32_16x16x32_bf16 v[184:187], v[84:87], v[32:35], v[184:187]
    s_add_u32 s75, s75, 9216
    s_add_u32 m0, s74, 1024
    v_mfma_f32_16x16x32_bf16 v[188:191], v[88:91], v[32:35], v[188:191]
    s_waitcnt vmcnt(5)
    buffer_load_dwordx4 v7, s[48:51], s75 offen lds
    v_mfma_f32_16x16x32_bf16 v[192:195], v[72:75], v[36:39], v[192:195]
    s_add_u32 s75, s75, 9216
    s_add_u32 m0, s74, 2048
    v_mfma_f32_16x16x32_bf16 v[196:199], v[76:79], v[36:39], v[196:199]
    s_waitcnt vmcnt(5)
    buffer_load_dwordx4 v7, s[48:51], s75 offen lds
    v_mfma_f32_16x16x32_bf16 v[200:203], v[80:83], v[36:39], v[200:203]
    s_add_u32 s75, s75, 9216
    s_add_u32 m0, s74, 3072
    v_mfma_f32_16x16x32_bf16 v[204:207], v[84:87], v[36:39], v[204:207]
    s_waitcnt vmcnt(5)
    buffer_load_dwordx4 v7, s[48:51], s75 offen lds
    v_mfma_f32_16x16x32_bf16 v[208:211], v[72:75], v[40:43], v[208:211]
    v_mfma_f32_16x16x32_bf16 v[212:215], v[76:79], v[40:43], v[212:215]
    v_mfma_f32_16x16x32_bf16 v[216:219], v[80:83], v[40:43], v[216:219]
    v_mfma_f32_16x16x32_bf16 v[220:223], v[84:87], v[40:43], v[220:223]
    v_mfma_f32_16x16x32_bf16 v[224:227], v[72:75], v[44:47], v[224:227]
    v_mfma_f32_16x16x32_bf16 v[228:231], v[76:79], v[44:47], v[228:231]
    v_mfma_f32_16x16x32_bf16 v[232:235], v[80:83], v[44:47], v[232:235]
    v_mfma_f32_16x16x32_bf16 v[236:239], v[84:87], v[44:47], v[236:239]
    s_waitcnt vmcnt(5)
    v_mfma_f32_16x16x32_bf16 v[240:243], v[72:75], v[48:51], v[240:243]
    v_mfma_f32_16x16x32_bf16 v[244:247], v[76:79], v[48:51], v[244:247]
    v_mfma_f32_16x16x32_bf16 v[248:251], v[80:83], v[48:51], v[248:251]
    v_mfma_f32_16x16x32_bf16 v[252:255], v[84:87], v[48:51], v[252:255]
    s_nop 7
    s_branch L_O_next
L_O_free:
    s_add_u32 s76, s71, s6
    buffer_load_dwordx4 v[16:19], v4, s[60:63], s76 offen offset:0 sc1
    buffer_load_dwordx4 v[20:23], v4, s[60:63], s76 offen offset:1024 sc1
    buffer_load_dwordx4 v[24:27], v4, s[60:63], s76 offen offset:2048 sc1
    buffer_load_dwordx4 v[28:31], v4, s[60:63], s76 offen offset:3072 sc1
    buffer_load_dwordx4 v[32:35], v5, s[60:63], s76 offen sc1
    buffer_load_dwordx4 v[36:39], v6, s[60:63], s76 offen offset:0 sc1
    buffer_load_dwordx4 v[40:43], v6, s[60:63], s76 offen offset:1024 sc1
    buffer_load_dwordx4 v[44:47], v6, s[60:63], s76 offen offset:2048 sc1
    buffer_load_dwordx4 v[48:51], v6, s[60:63], s76 offen offset:3072 sc1
    s_waitcnt lgkmcnt(0)
    s_waitcnt vmcnt(8)
    v_mfma_f32_16x16x32_bf16 v[92:95], v[52:55], v[16:19], v[92:95]
    s_add_u32 s76, s71, s7
    v_mfma_f32_16x16x32_bf16 v[96:99], v[56:59], v[16:19], v[96:99]
    ds_read_b64_tr_b16 v[72:73], v9 offset:5120
    v_mfma_f32_16x16x32_bf16 v[100:103], v[60:63], v[16:19], v[100:103]
    ds_read_b64_tr_b16 v[74:75], v9 offset:7168
    v_mfma_f32_16x16x32_bf16 v[104:107], v[64:67], v[16:19], v[104:107]
    ds_read_b64_tr_b16 v[76:77], v10 offset:5120
    v_mfma_f32_16x16x32_bf16 v[108:111], v[68:71], v[16:19], v[108:111]
    buffer_load_dwordx4 v[16:19], v4, s[60:63], s76 offen offset:0 sc1
    s_waitcnt vmcnt(8)
    v_mfma_f32_16x16x32_bf16 v[112:115], v[52:55], v[20:23], v[112:115]
    ds_read_b64_tr_b16 v[78:79], v10 offset:7168
    v_mfma_f32_16x16x32_bf16 v[116:119], v[56:59], v[20:23], v[116:119]
    ds_read_b64_tr_b16 v[80:81], v11 offset:5120
    v_mfma_f32_16x16x32_bf16 v[120:123], v[60:63], v[20:23], v[120:123]
    ds_read_b64_tr_b16 v[82:83], v11 offset:7168
    v_mfma_f32_16x16x32_bf16 v[124:127], v[64:67], v[20:23], v[124:127]
    ds_read_b64_tr_b16 v[84:85], v12 offset:5120
    v_mfma_f32_16x16x32_bf16 v[128:131], v[68:71], v[20:23], v[128:131]
    buffer_load_dwordx4 v[20:23], v4, s[60:63], s76 offen offset:1024 sc1
    s_waitcnt vmcnt(8)
    v_mfma_f32_16x16x32_bf16 v[132:135], v[52:55], v[24:27], v[132:135]
    ds_read_b64_tr_b16 v[86:87], v12 offset:7168
    v_mfma_f32_16x16x32_bf16 v[136:139], v[56:59], v[24:27], v[136:139]
    ds_read_b64_tr_b16 v[88:89], v13 offset:9216
    v_mfma_f32_16x16x32_bf16 v[140:143], v[60:63], v[24:27], v[140:143]
    ds_read_b64_tr_b16 v[90:91], v13 offset:9728
    v_mfma_f32_16x16x32_bf16 v[144:147], v[64:67], v[24:27], v[144:147]
    v_mfma_f32_16x16x32_bf16 v[148:151], v[68:71], v[24:27], v[148:151]
    buffer_load_dwordx4 v[24:27], v4, s[60:63], s76 offen offset:2048 sc1
    s_waitcnt vmcnt(8)
    v_mfma_f32_16x16x32_bf16 v[152:155], v[52:55], v[28:31], v[152:155]
    v_mfma_f32_16x16x32_bf16 v[156:159], v[56:59], v[28:31], v[156:159]
    v_mfma_f32_16x16x32_bf16 v[160:163], v[60:63], v[28:31], v[160:163]
    v_mfma_f32_16x16x32_bf16 v[164:167], v[64:67], v[28:31], v[164:167]
    s_waitcnt lgkmcnt(0)
    s_lshl2_add_u32 s75, s9, s72
    s_add_u32 m0, s74, 9216
    v_mfma_f32_16x16x32_bf16 v[168:171], v[68:71], v[28:31], v[168:171]
    buffer_load_dwordx4 v[28:31], v4, s[60:63], s76 offen offset:3072 sc1
    s_waitcnt vmcnt(8)
    v_mfma_f32_16x16x32_bf16 v[172:175], v[52:55], v[32:35], v[172:175]
    s_lshr_b32 s85, s75, 12
    s_mul_hi_u32 s85, s85, s97
    s_lshl_b32 s85, s85, 10
    v_mfma_f32_16x16x32_bf16 v[176:179], v[56:59], v[32:35], v[176:179]
    buffer_load_dwordx4 v8, s[60:63], s85 offen sc1 lds
    v_mfma_f32_16x16x32_bf16 v[180:183], v[60:63], v[32:35], v[180:183]
    s_add_u32 m0, s74, 5120
    v_mfma_f32_16x16x32_bf16 v[184:187], v[64:67], v[32:35], v[184:187]
    buffer_load_dwordx4 v7, s[48:51], s75 offen lds
    v_mfma_f32_16x16x32_bf16 v[188:191], v[68:71], v[32:35], v[188:191]
    buffer_load_dwordx4 v[32:35], v5, s[60:63], s76 offen sc1
    s_waitcnt vmcnt(10)
    v_mfma_f32_16x16x32_bf16 v[192:195], v[52:55], v[36:39], v[192:195]
    s_add_u32 s75, s75, 9216
    s_add_u32 m0, s74, 6144
    v_mfma_f32_16x16x32_bf16 v[196:199], v[56:59], v[36:39], v[196:199]
    buffer_load_dwordx4 v7, s[48:51], s75 offen lds
    v_mfma_f32_16x16x32_bf16 v[200:203], v[60:63], v[36:39], v[200:203]
    s_add_u32 s75, s75, 9216
    s_add_u32 m0, s74, 7168
    v_mfma_f32_16x16x32_bf16 v[204:207], v[64:67], v[36:39], v[204:207]
    buffer_load_dwordx4 v[36:39], v6, s[60:63], s76 offen offset:0 sc1
    s_waitcnt vmcnt(11)
    v_mfma_f32_16x16x32_bf16 v[208:211], v[52:55], v[40:43], v[208:211]
    buffer_load_dwordx4 v7, s[48:51], s75 offen lds
    v_mfma_f32_16x16x32_bf16 v[212:215], v[56:59], v[40:43], v[212:215]
    s_add_u32 s75, s75, 9216
    s_add_u32 m0, s74, 8192
    v_mfma_f32_16x16x32_bf16 v[216:219], v[60:63], v[40:43], v[216:219]
    buffer_load_dwordx4 v7, s[48:51], s75 offen lds
    v_mfma_f32_16x16x32_bf16 v[220:223], v[64:67], v[40:43], v[220:223]
    buffer_load_dwordx4 v[40:43], v6, s[60:63], s76 offen offset:1024 sc1
    s_waitcnt vmcnt(13)
    v_mfma_f32_16x16x32_bf16 v[224:227], v[52:55], v[44:47], v[224:227]
    v_mfma_f32_16x16x32_bf16 v[228:231], v[56:59], v[44:47], v[228:231]
    v_mfma_f32_16x16x32_bf16 v[232:235], v[60:63], v[44:47], v[232:235]
    v_mfma_f32_16x16x32_bf16 v[236:239], v[64:67], v[44:47], v[236:239]
    buffer_load_dwordx4 v[44:47], v6, s[60:63], s76 offen offset:2048 sc1
    s_waitcnt vmcnt(13)
    v_mfma_f32_16x16x32_bf16 v[240:243], v[52:55], v[48:51], v[240:243]
    v_mfma_f32_16x16x32_bf16 v[244:247], v[56:59], v[48:51], v[244:247]
    v_mfma_f32_16x16x32_bf16 v[248:251], v[60:63], v[48:51], v[248:251]
    v_mfma_f32_16x16x32_bf16 v[252:255], v[64:67], v[48:51], v[252:255]
    buffer_load_dwordx4 v[48:51], v6, s[60:63], s76 offen offset:3072 sc1
    s_waitcnt vmcnt(13)
    v_mfma_f32_16x16x32_bf16 v[92:95], v[72:75], v[16:19], v[92:95]
    s_add_u32 s76, s71, s8
    v_mfma_f32_16x16x32_bf16 v[96:99], v[76:79], v[16:19], v[96:99]
    ds_read_b64_tr_b16 v[52:53], v9 offset:0
    v_mfma_f32_16x16x32_bf16 v[100:103], v[80:83], v[16:19], v[100:103]
    ds_read_b64_tr_b16 v[54:55], v9 offset:2048
    v_mfma_f32_16x16x32_bf16 v[104:107], v[84:87], v[16:19], v[104:107]
    ds_read_b64_tr_b16 v[56:57], v10 offset:0
    v_mfma_f32_16x16x32_bf16 v[108:111], v[88:91], v[16:19], v[108:111]
    buffer_load_dwordx4 v[16:19], v4, s[60:63], s76 offen offset:0 sc1
    s_waitcnt vmcnt(13)
    v_mfma_f32_16x16x32_bf16 v[112:115], v[72:75], v[20:23], v[112:115]
    ds_read_b64_tr_b16 v[58:59], v10 offset:2048
    v_mfma_f32_16x16x32_bf16 v[116:119], v[76:79], v[20:23], v[116:119]
    ds_read_b64_tr_b16 v[60:61], v11 offset:0
    v_mfma_f32_16x16x32_bf16 v[120:123], v[80:83], v[20:23], v[120:123]
    ds_read_b64_tr_b16 v[62:63], v11 offset:2048
    v_mfma_f32_16x16x32_bf16 v[124:127], v[84:87], v[20:23], v[124:127]
    ds_read_b64_tr_b16 v[64:65], v12 offset:0
    v_mfma_f32_16x16x32_bf16 v[128:131], v[88:91], v[20:23], v[128:131]
    buffer_load_dwordx4 v[20:23], v4, s[60:63], s76 offen offset:1024 sc1
    s_waitcnt vmcnt(13)
    v_mfma_f32_16x16x32_bf16 v[132:135], v[72:75], v[24:27], v[132:135]
    ds_read_b64_tr_b16 v[66:67], v12 offset:2048
    v_mfma_f32_16x16x32_bf16 v[136:139], v[76:79], v[24:27], v[136:139]
    ds_read_b64_tr_b16 v[68:69], v13 offset:4096
    v_mfma_f32_16x16x32_bf16 v[140:143], v[80:83], v[24:27], v[140:143]
    ds_read_b64_tr_b16 v[70:71], v13 offset:4608
    v_mfma_f32_16x16x32_bf16 v[144:147], v[84:87], v[24:27], v[144:147]
    v_mfma_f32_16x16x32_bf16 v[148:151], v[88:91], v[24:27], v[148:151]
    buffer_load_dwordx4 v[24:27], v4, s[60:63], s76 offen offset:2048 sc1
    s_waitcnt vmcnt(13)
    v_mfma_f32_16x16x32_bf16 v[152:155], v[72:75], v[28:31], v[152:155]
    v_mfma_f32_16x16x32_bf16 v[156:159], v[76:79], v[28:31], v[156:159]
    v_mfma_f32_16x16x32_bf16 v[160:163], v[80:83], v[28:31], v[160:163]
    v_mfma_f32_16x16x32_bf16 v[164:167], v[84:87], v[28:31], v[164:167]
    s_waitcnt lgkmcnt(0)
    s_lshl2_add_u32 s75, s10, s72
    s_add_u32 m0, s74, 4096
    v_mfma_f32_16x16x32_bf16 v[168:171], v[88:91], v[28:31], v[168:171]
    buffer_load_dwordx4 v[28:31], v4, s[60:63], s76 offen offset:3072 sc1
    s_waitcnt vmcnt(11)
    v_mfma_f32_16x16x32_bf16 v[172:175], v[72:75], v[32:35], v[172:175]
    s_lshr_b32 s85, s75, 12
    s_mul_hi_u32 s85, s85, s97
    s_lshl_b32 s85, s85, 10
    v_mfma_f32_16x16x32_bf16 v[176:179], v[76:79], v[32:35], v[176:179]
    buffer_load_dwordx4 v8, s[60:63], s85 offen sc1 lds
    v_mfma_f32_16x16x32_bf16 v[180:183], v[80:83], v[32:35], v[180:183]
    s_add_u32 m0, s74, 0
    v_mfma_f32_16x16x32_bf16 v[184:187], v[84:87], v[32:35], v[184:187]
    buffer_load_dwordx4 v7, s[48:51], s75 offen lds
    v_mfma_f32_16x16x32_bf16 v[188:191], v[88:91], v[32:35], v[188:191]
    buffer_load_dwordx4 v[32:35], v5, s[60:63], s76 offen sc1
    s_waitcnt vmcnt(12)
    v_mfma_f32_16x16x32_bf16 v[192:195], v[72:75], v[36:39], v[192:195]
    s_add_u32 s75, s75, 9216
    s_add_u32 m0, s74, 1024
    v_mfma_f32_16x16x32_bf16 v[196:199], v[76:79], v[36:39], v[196:199]
    buffer_load_dwordx4 v7, s[48:51], s75 offen lds
    v_mfma_f32_16x16x32_bf16 v[200:203], v[80:83], v[36:39], v[200:203]
    s_add_u32 s75, s75, 9216
    s_add_u32 m0, s74, 2048
    v_mfma_f32_16x16x32_bf16 v[204:207], v[84:87], v[36:39], v[204:207]
    buffer_load_dwordx4 v[36:39], v6, s[60:63], s76 offen offset:0 sc1
    s_waitcnt vmcnt(11)
    v_mfma_f32_16x16x32_bf16 v[208:211], v[72:75], v[40:43], v[208:211]
    buffer_load_dwordx4 v7, s[48:51], s75 offen lds
    v_mfma_f32_16x16x32_bf16 v[212:215], v[76:79], v[40:43], v[212:215]
    s_add_u32 s75, s75, 9216
    s_add_u32 m0, s74, 3072
    v_mfma_f32_16x16x32_bf16 v[216:219], v[80:83], v[40:43], v[216:219]
    buffer_load_dwordx4 v7, s[48:51], s75 offen lds
    v_mfma_f32_16x16x32_bf16 v[220:223], v[84:87], v[40:43], v[220:223]
    buffer_load_dwordx4 v[40:43], v6, s[60:63], s76 offen offset:1024 sc1
    s_waitcnt vmcnt(13)
    v_mfma_f32_16x16x32_bf16 v[224:227], v[72:75], v[44:47], v[224:227]
    v_mfma_f32_16x16x32_bf16 v[228:231], v[76:79], v[44:47], v[228:231]
    v_mfma_f32_16x16x32_bf16 v[232:235], v[80:83], v[44:47], v[232:235]
    v_mfma_f32_16x16x32_bf16 v[236:239], v[84:87], v[44:47], v[236:239]
    buffer_load_dwordx4 v[44:47], v6, s[60:63], s76 offen offset:2048 sc1
    s_waitcnt vmcnt(13)
    v_mfma_f32_16x16x32_bf16 v[240:243], v[72:75], v[48:51], v[240:243]
    v_mfma_f32_16x16x32_bf16 v[244:247], v[76:79], v[48:51], v[244:247]
    v_mfma_f32_16x16x32_bf16 v[248:251], v[80:83], v[48:51], v[248:251]
    v_mfma_f32_16x16x32_bf16 v[252:255], v[84:87], v[48:51], v[252:255]
    buffer_load_dwordx4 v[48:51], v6, s[60:63], s76 offen offset:3072 sc1
    s_waitcnt vmcnt(13)
    v_mfma_f32_16x16x32_bf16 v[92:95], v[52:55], v[16:19], v[92:95]
    s_add_u32 s76, s71, s9
    v_mfma_f32_16x16x32_bf16 v[96:99], v[56:59], v[16:19], v[96:99]
    ds_read_b64_tr_b16 v[72:73], v9 offset:5120
    v_mfma_f32_16x16x32_bf16 v[100:103], v[60:63], v[16:19], v[100:103]
    ds_read_b64_tr_b16 v[74:75], v9 offset:7168
    v_mfma_f32_16x16x32_bf16 v[104:107], v[64:67], v[16:19], v[104:107]
    ds_read_b64_tr_b16 v[76:77], v10 offset:5120
    v_mfma_f32_16x16x32_bf16 v[108:111], v[68:71], v[16:19], v[108:111]
    buffer_load_dwordx4 v[16:19], v4, s[60:63], s76 offen offset:0 sc1
    s_waitcnt vmcnt(13)
    v_mfma_f32_16x16x32_bf16 v[112:115], v[52:55], v[20:23], v[112:115]
    ds_read_b64_tr_b16 v[78:79], v10 offset:7168
    v_mfma_f32_16x16x32_bf16 v[116:119], v[56:59], v[20:23], v[116:119]
    ds_read_b64_tr_b16 v[80:81], v11 offset:5120
    v_mfma_f32_16x16x32_bf16 v[120:123], v[60:63], v[20:23], v[120:123]
    ds_read_b64_tr_b16 v[82:83], v11 offset:7168
    v_mfma_f32_16x16x32_bf16 v[124:127], v[64:67], v[20:23], v[124:127]
    ds_read_b64_tr_b16 v[84:85], v12 offset:5120
    v_mfma_f32_16x16x32_bf16 v[128:131], v[68:71], v[20:23], v[128:131]
    buffer_load_dwordx4 v[20:23], v4, s[60:63], s76 offen offset:1024 sc1
    s_waitcnt vmcnt(13)
    v_mfma_f32_16x16x32_bf16 v[132:135], v[52:55], v[24:27], v[132:135]
    ds_read_b64_tr_b16 v[86:87], v12 offset:7168
    v_mfma_f32_16x16x32_bf16 v[136:139], v[56:59], v[24:27], v[136:139]
    ds_read_b64_tr_b16 v[88:89], v13 offset:9216
    v_mfma_f32_16x16x32_bf16 v[140:143], v[60:63], v[24:27], v[140:143]
    ds_read_b64_tr_b16 v[90:91], v13 offset:9728
    v_mfma_f32_16x16x32_bf16 v[144:147], v[64:67], v[24:27], v[144:147]
    v_mfma_f32_16x16x32_bf16 v[148:151], v[68:71], v[24:27], v[148:151]
    buffer_load_dwordx4 v[24:27], v4, s[60:63], s76 offen offset:2048 sc1
    s_waitcnt vmcnt(13)
    v_mfma_f32_16x16x32_bf16 v[152:155], v[52:55], v[28:31], v[152:155]
    v_mfma_f32_16x16x32_bf16 v[156:159], v[56:59], v[28:31], v[156:159]
    v_mfma_f32_16x16x32_bf16 v[160:163], v[60:63], v[28:31], v[160:163]
    v_mfma_f32_16x16x32_bf16 v[164:167], v[64:67], v[28:31], v[164:167]
    s_waitcnt lgkmcnt(0)
    s_lshl2_add_u32 s75, s11, s72
    s_add_u32 m0, s74, 9216
    v_mfma_f32_16x16x32_bf16 v[168:171], v[68:71], v[28:31], v[168:171]
    buffer_load_dwordx4 v[28:31], v4, s[60:63], s76 offen offset:3072 sc1
    s_waitcnt vmcnt(11)
    v_mfma_f32_16x16x32_bf16 v[172:175], v[52:55], v[32:35], v[172:175]
    s_lshr_b32 s85, s75, 12
    s_mul_hi_u32 s85, s85, s97
    s_lshl_b32 s85, s85, 10
    v_mfma_f32_16x16x32_bf16 v[176:179], v[56:59], v[32:35], v[176:179]
    buffer_load_dwordx4 v8, s[60:63], s85 offen sc1 lds
    v_mfma_f32_16x16x32_bf16 v[180:183], v[60:63], v[32:35], v[180:183]
    s_add_u32 m0, s74, 5120
    v_mfma_f32_16x16x32_bf16 v[184:187], v[64:67], v[32:35], v[184:187]
    buffer_load_dwordx4 v7, s[48:51], s75 offen lds
    v_mfma_f32_16x16x32_bf16 v[188:191], v[68:71], v[32:35], v[188:191]
    buffer_load_dwordx4 v[32:35], v5, s[60:63], s76 offen sc1
    s_waitcnt vmcnt(12)
    v_mfma_f32_16x16x32_bf16 v[192:195], v[52:55], v[36:39], v[192:195]
    s_add_u32 s75, s75, 9216
    s_add_u32 m0, s74, 6144
    v_mfma_f32_16x16x32_bf16 v[196:199], v[56:59], v[36:39], v[196:199]
    buffer_load_dwordx4 v7, s[48:51], s75 offen lds
    v_mfma_f32_16x16x32_bf16 v[200:203], v[60:63], v[36:39], v[200:203]
    s_add_u32 s75, s75, 9216
    s_add_u32 m0, s74, 7168
    v_mfma_f32_16x16x32_bf16 v[204:207], v[64:67], v[36:39], v[204:207]
    buffer_load_dwordx4 v[36:39], v6, s[60:63], s76 offen offset:0 sc1
    s_waitcnt vmcnt(11)
    v_mfma_f32_16x16x32_bf16 v[208:211], v[52:55], v[40:43], v[208:211]
    buffer_load_dwordx4 v7, s[48:51], s75 offen lds
    v_mfma_f32_16x16x32_bf16 v[212:215], v[56:59], v[40:43], v[212:215]
    s_add_u32 s75, s75, 9216
    s_add_u32 m0, s74, 8192
    v_mfma_f32_16x16x32_bf16 v[216:219], v[60:63], v[40:43], v[216:219]
    buffer_load_dwordx4 v7, s[48:51], s75 offen lds
    v_mfma_f32_16x16x32_bf16 v[220:223], v[64:67], v[40:43], v[220:223]
    buffer_load_dwordx4 v[40:43], v6, s[60:63], s76 offen offset:1024 sc1
    s_waitcnt vmcnt(13)
    v_mfma_f32_16x16x32_bf16 v[224:227], v[52:55], v[44:47], v[224:227]
    v_mfma_f32_16x16x32_bf16 v[228:231], v[56:59], v[44:47], v[228:231]
    v_mfma_f32_16x16x32_bf16 v[232:235], v[60:63], v[44:47], v[232:235]
    v_mfma_f32_16x16x32_bf16 v[236:239], v[64:67], v[44:47], v[236:239]
    buffer_load_dwordx4 v[44:47], v6, s[60:63], s76 offen offset:2048 sc1
    s_waitcnt vmcnt(13)
    v_mfma_f32_16x16x32_bf16 v[240:243], v[52:55], v[48:51], v[240:243]
    v_mfma_f32_16x16x32_bf16 v[244:247], v[56:59], v[48:51], v[244:247]
    v_mfma_f32_16x16x32_bf16 v[248:251], v[60:63], v[48:51], v[248:251]
    v_mfma_f32_16x16x32_bf16 v[252:255], v[64:67], v[48:51], v[252:255]
    buffer_load_dwordx4 v[48:51], v6, s[60:63], s76 offen offset:3072 sc1
    s_waitcnt vmcnt(13)
    v_mfma_f32_16x16x32_bf16 v[92:95], v[72:75], v[16:19], v[92:95]
    s_add_u32 s76, s71, s10
    v_mfma_f32_16x16x32_bf16 v[96:99], v[76:79], v[16:19], v[96:99]
    ds_read_b64_tr_b16 v[52:53], v9 offset:0
    v_mfma_f32_16x16x32_bf16 v[100:103], v[80:83], v[16:19], v[100:103]
    ds_read_b64_tr_b16 v[54:55], v9 offset:2048
    v_mfma_f32_16x16x32_bf16 v[104:107], v[84:87], v[16:19], v[104:107]
    ds_read_b64_tr_b16 v[56:57], v10 offset:0
    v_mfma_f32_16x16x32_bf16 v[108:111], v[88:91], v[16:19], v[108:111]
    buffer_load_dwordx4 v[16:19], v4, s[60:63], s76 offen offset:0 sc1
    s_waitcnt vmcnt(13)
    v_mfma_f32_16x16x32_bf16 v[112:115], v[72:75], v[20:23], v[112:115]
    ds_read_b64_tr_b16 v[58:59], v10 offset:2048
    v_mfma_f32_16x16x32_bf16 v[116:119], v[76:79], v[20:23], v[116:119]
    ds_read_b64_tr_b16 v[60:61], v11 offset:0
    v_mfma_f32_16x16x32_bf16 v[120:123], v[80:83], v[20:23], v[120:123]
    ds_read_b64_tr_b16 v[62:63], v11 offset:2048
    v_mfma_f32_16x16x32_bf16 v[124:127], v[84:87], v[20:23], v[124:127]
    ds_read_b64_tr_b16 v[64:65], v12 offset:0
    v_mfma_f32_16x16x32_bf16 v[128:131], v[88:91], v[20:23], v[128:131]
    buffer_load_dwordx4 v[20:23], v4, s[60:63], s76 offen offset:1024 sc1
    s_waitcnt vmcnt(13)
    v_mfma_f32_16x16x32_bf16 v[132:135], v[72:75], v[24:27], v[132:135]
    ds_read_b64_tr_b16 v[66:67], v12 offset:2048
    v_mfma_f32_16x16x32_bf16 v[136:139], v[76:79], v[24:27], v[136:139]
    ds_read_b64_tr_b16 v[68:69], v13 offset:4096
    v_mfma_f32_16x16x32_bf16 v[140:143], v[80:83], v[24:27], v[140:143]
    ds_read_b64_tr_b16 v[70:71], v13 offset:4608
    v_mfma_f32_16x16x32_bf16 v[144:147], v[84:87], v[24:27], v[144:147]
    v_mfma_f32_16x16x32_bf16 v[148:151], v[88:91], v[24:27], v[148:151]
    buffer_load_dwordx4 v[24:27], v4, s[60:63], s76 offen offset:2048 sc1
    s_waitcnt vmcnt(13)
    v_mfma_f32_16x16x32_bf16 v[152:155], v[72:75], v[28:31], v[152:155]
    v_mfma_f32_16x16x32_bf16 v[156:159], v[76:79], v[28:31], v[156:159]
    v_mfma_f32_16x16x32_bf16 v[160:163], v[80:83], v[28:31], v[160:163]
    v_mfma_f32_16x16x32_bf16 v[164:167], v[84:87], v[28:31], v[164:167]
    s_waitcnt lgkmcnt(0)
    s_lshl2_add_u32 s75, s12, s72
    s_add_u32 m0, s74, 4096
    v_mfma_f32_16x16x32_bf16 v[168:171], v[88:91], v[28:31], v[168:171]
    buffer_load_dwordx4 v[28:31], v4, s[60:63], s76 offen offset:3072 sc1
    s_waitcnt vmcnt(11)
    v_mfma_f32_16x16x32_bf16 v[172:175], v[72:75], v[32:35], v[172:175]
    s_lshr_b32 s85, s75, 12
    s_mul_hi_u32 s85, s85, s97
    s_lshl_b32 s85, s85, 10
    v_mfma_f32_16x16x32_bf16 v[176:179], v[76:79], v[32:35], v[176:179]
    buffer_load_dwordx4 v8, s[60:63], s85 offen sc1 lds
    v_mfma_f32_16x16x32_bf16 v[180:183], v[80:83], v[32:35], v[180:183]
    s_add_u32 m0, s74, 0
    v_mfma_f32_16x16x32_bf16 v[184:187], v[84:87], v[32:35], v[184:187]
    buffer_load_dwordx4 v7, s[48:51], s75 offen lds
    v_mfma_f32_16x16x32_bf16 v[188:191], v[88:91], v[32:35], v[188:191]
    buffer_load_dwordx4 v[32:35], v5, s[60:63], s76 offen sc1
    s_waitcnt vmcnt(12)
    v_mfma_f32_16x16x32_bf16 v[192:195], v[72:75], v[36:39], v[192:195]
    s_add_u32 s75, s75, 9216
    s_add_u32 m0, s74, 1024
    v_mfma_f32_16x16x32_bf16 v[196:199], v[76:79], v[36:39], v[196:199]
    buffer_load_dwordx4 v7, s[48:51], s75 offen lds
    v_mfma_f32_16x16x32_bf16 v[200:203], v[80:83], v[36:39], v[200:203]
    s_add_u32 s75, s75, 9216
    s_add_u32 m0, s74, 2048
    v_mfma_f32_16x16x32_bf16 v[204:207], v[84:87], v[36:39], v[204:207]
    buffer_load_dwordx4 v[36:39], v6, s[60:63], s76 offen offset:0 sc1
    s_waitcnt vmcnt(11)
    v_mfma_f32_16x16x32_bf16 v[208:211], v[72:75], v[40:43], v[208:211]
    buffer_load_dwordx4 v7, s[48:51], s75 offen lds
    v_mfma_f32_16x16x32_bf16 v[212:215], v[76:79], v[40:43], v[212:215]
    s_add_u32 s75, s75, 9216
    s_add_u32 m0, s74, 3072
    v_mfma_f32_16x16x32_bf16 v[216:219], v[80:83], v[40:43], v[216:219]
    buffer_load_dwordx4 v7, s[48:51], s75 offen lds
    v_mfma_f32_16x16x32_bf16 v[220:223], v[84:87], v[40:43], v[220:223]
    buffer_load_dwordx4 v[40:43], v6, s[60:63], s76 offen offset:1024 sc1
    s_waitcnt vmcnt(13)
    v_mfma_f32_16x16x32_bf16 v[224:227], v[72:75], v[44:47], v[224:227]
    v_mfma_f32_16x16x32_bf16 v[228:231], v[76:79], v[44:47], v[228:231]
    v_mfma_f32_16x16x32_bf16 v[232:235], v[80:83], v[44:47], v[232:235]
    v_mfma_f32_16x16x32_bf16 v[236:239], v[84:87], v[44:47], v[236:239]
    buffer_load_dwordx4 v[44:47], v6, s[60:63], s76 offen offset:2048 sc1
    s_waitcnt vmcnt(13)
    v_mfma_f32_16x16x32_bf16 v[240:243], v[72:75], v[48:51], v[240:243]
    v_mfma_f32_16x16x32_bf16 v[244:247], v[76:79], v[48:51], v[244:247]
    v_mfma_f32_16x16x32_bf16 v[248:251], v[80:83], v[48:51], v[248:251]
    v_mfma_f32_16x16x32_bf16 v[252:255], v[84:87], v[48:51], v[252:255]
    buffer_load_dwordx4 v[48:51], v6, s[60:63], s76 offen offset:3072 sc1
    s_waitcnt vmcnt(13)
    v_mfma_f32_16x16x32_bf16 v[92:95], v[52:55], v[16:19], v[92:95]
    s_add_u32 s76, s71, s11
    v_mfma_f32_16x16x32_bf16 v[96:99], v[56:59], v[16:19], v[96:99]
    ds_read_b64_tr_b16 v[72:73], v9 offset:5120
    v_mfma_f32_16x16x32_bf16 v[100:103], v[60:63], v[16:19], v[100:103]
    ds_read_b64_tr_b16 v[74:75], v9 offset:7168
    v_mfma_f32_16x16x32_bf16 v[104:107], v[64:67], v[16:19], v[104:107]
    ds_read_b64_tr_b16 v[76:77], v10 offset:5120
    v_mfma_f32_16x16x32_bf16 v[108:111], v[68:71], v[16:19], v[108:111]
    buffer_load_dwordx4 v[16:19], v4, s[60:63], s76 offen offset:0 sc1
    s_waitcnt vmcnt(13)
    v_mfma_f32_16x16x32_bf16 v[112:115], v[52:55], v[20:23], v[112:115]
    ds_read_b64_tr_b16 v[78:79], v10 offset:7168
    v_mfma_f32_16x16x32_bf16 v[116:119], v[56:59], v[20:23], v[116:119]
    ds_read_b64_tr_b16 v[80:81], v11 offset:5120
    v_mfma_f32_16x16x32_bf16 v[120:123], v[60:63], v[20:23], v[120:123]
    ds_read_b64_tr_b16 v[82:83], v11 offset:7168
    v_mfma_f32_16x16x32_bf16 v[124:127], v[64:67], v[20:23], v[124:127]
    ds_read_b64_tr_b16 v[84:85], v12 offset:5120
    v_mfma_f32_16x16x32_bf16 v[128:131], v[68:71], v[20:23], v[128:131]
    buffer_load_dwordx4 v[20:23], v4, s[60:63], s76 offen offset:1024 sc1
    s_waitcnt vmcnt(13)
    v_mfma_f32_16x16x32_bf16 v[132:135], v[52:55], v[24:27], v[132:135]
    ds_read_b64_tr_b16 v[86:87], v12 offset:7168
    v_mfma_f32_16x16x32_bf16 v[136:139], v[56:59], v[24:27], v[136:139]
    ds_read_b64_tr_b16 v[88:89], v13 offset:9216
    v_mfma_f32_16x16x32_bf16 v[140:143], v[60:63], v[24:27], v[140:143]
    ds_read_b64_tr_b16 v[90:91], v13 offset:9728
    v_mfma_f32_16x16x32_bf16 v[144:147], v[64:67], v[24:27], v[144:147]
    v_mfma_f32_16x16x32_bf16 v[148:151], v[68:71], v[24:27], v[148:151]
    buffer_load_dwordx4 v[24:27], v4, s[60:63], s76 offen offset:2048 sc1
    s_waitcnt vmcnt(13)
    v_mfma_f32_16x16x32_bf16 v[152:155], v[52:55], v[28:31], v[152:155]
    v_mfma_f32_16x16x32_bf16 v[156:159], v[56:59], v[28:31], v[156:159]
    v_mfma_f32_16x16x32_bf16 v[160:163], v[60:63], v[28:31], v[160:163]
    v_mfma_f32_16x16x32_bf16 v[164:167], v[64:67], v[28:31], v[164:167]
    s_waitcnt lgkmcnt(0)
    s_lshl2_add_u32 s75, s13, s72
    s_add_u32 m0, s74, 9216
    v_mfma_f32_16x16x32_bf16 v[168:171], v[68:71], v[28:31], v[168:171]
    buffer_load_dwordx4 v[28:31], v4, s[60:63], s76 offen offset:3072 sc1
    s_waitcnt vmcnt(11)
    v_mfma_f32_16x16x32_bf16 v[172:175], v[52:55], v[32:35], v[172:175]
    s_lshr_b32 s85, s75, 12
    s_mul_hi_u32 s85, s85, s97
    s_lshl_b32 s85, s85, 10
    v_mfma_f32_16x16x32_bf16 v[176:179], v[56:59], v[32:35], v[176:179]
    buffer_load_dwordx4 v8, s[60:63], s85 offen sc1 lds
    v_mfma_f32_16x16x32_bf16 v[180:183], v[60:63], v[32:35], v[180:183]
    s_add_u32 m0, s74, 5120
    v_mfma_f32_16x16x32_bf16 v[184:187], v[64:67], v[32:35], v[184:187]
    buffer_load_dwordx4 v7, s[48:51], s75 offen lds
    v_mfma_f32_16x16x32_bf16 v[188:191], v[68:71], v[32:35], v[188:191]
    buffer_load_dwordx4 v[32:35], v5, s[60:63], s76 offen sc1
    s_waitcnt vmcnt(12)
    v_mfma_f32_16x16x32_bf16 v[192:195], v[52:55], v[36:39], v[192:195]
    s_add_u32 s75, s75, 9216
    s_add_u32 m0, s74, 6144
    v_mfma_f32_16x16x32_bf16 v[196:199], v[56:59], v[36:39], v[196:199]
    buffer_load_dwordx4 v7, s[48:51], s75 offen lds
    v_mfma_f32_16x16x32_bf16 v[200:203], v[60:63], v[36:39], v[200:203]
    s_add_u32 s75, s75, 9216
    s_add_u32 m0, s74, 7168
    v_mfma_f32_16x16x32_bf16 v[204:207], v[64:67], v[36:39], v[204:207]
    buffer_load_dwordx4 v[36:39], v6, s[60:63], s76 offen offset:0 sc1
    s_waitcnt vmcnt(11)
    v_mfma_f32_16x16x32_bf16 v[208:211], v[52:55], v[40:43], v[208:211]
    buffer_load_dwordx4 v7, s[48:51], s75 offen lds
    v_mfma_f32_16x16x32_bf16 v[212:215], v[56:59], v[40:43], v[212:215]
    s_add_u32 s75, s75, 9216
    s_add_u32 m0, s74, 8192
    v_mfma_f32_16x16x32_bf16 v[216:219], v[60:63], v[40:43], v[216:219]
    buffer_load_dwordx4 v7, s[48:51], s75 offen lds
    v_mfma_f32_16x16x32_bf16 v[220:223], v[64:67], v[40:43], v[220:223]
    buffer_load_dwordx4 v[40:43], v6, s[60:63], s76 offen offset:1024 sc1
    s_waitcnt vmcnt(13)
    v_mfma_f32_16x16x32_bf16 v[224:227], v[52:55], v[44:47], v[224:227]
    v_mfma_f32_16x16x32_bf16 v[228:231], v[56:59], v[44:47], v[228:231]
    v_mfma_f32_16x16x32_bf16 v[232:235], v[60:63], v[44:47], v[232:235]
    v_mfma_f32_16x16x32_bf16 v[236:239], v[64:67], v[44:47], v[236:239]
    buffer_load_dwordx4 v[44:47], v6, s[60:63], s76 offen offset:2048 sc1
    s_waitcnt vmcnt(13)
    v_mfma_f32_16x16x32_bf16 v[240:243], v[52:55], v[48:51], v[240:243]
    v_mfma_f32_16x16x32_bf16 v[244:247], v[56:59], v[48:51], v[244:247]
    v_mfma_f32_16x16x32_bf16 v[248:251], v[60:63], v[48:51], v[248:251]
    v_mfma_f32_16x16x32_bf16 v[252:255], v[64:67], v[48:51], v[252:255]
    buffer_load_dwordx4 v[48:51], v6, s[60:63], s76 offen offset:3072 sc1
    s_waitcnt vmcnt(13)
    v_mfma_f32_16x16x32_bf16 v[92:95], v[72:75], v[16:19], v[92:95]
    s_add_u32 s76, s71, s12
    v_mfma_f32_16x16x32_bf16 v[96:99], v[76:79], v[16:19], v[96:99]
    ds_read_b64_tr_b16 v[52:53], v9 offset:0
    v_mfma_f32_16x16x32_bf16 v[100:103], v[80:83], v[16:19], v[100:103]
    ds_read_b64_tr_b16 v[54:55], v9 offset:2048
    v_mfma_f32_16x16x32_bf16 v[104:107], v[84:87], v[16:19], v[104:107]
    ds_read_b64_tr_b16 v[56:57], v10 offset:0
    v_mfma_f32_16x16x32_bf16 v[108:111], v[88:91], v[16:19], v[108:111]
    buffer_load_dwordx4 v[16:19], v4, s[60:63], s76 offen offset:0 sc1
    s_waitcnt vmcnt(13)
    v_mfma_f32_16x16x32_bf16 v[112:115], v[72:75], v[20:23], v[112:115]
    ds_read_b64_tr_b16 v[58:59], v10 offset:2048
    v_mfma_f32_16x16x32_bf16 v[116:119], v[76:79], v[20:23], v[116:119]
    ds_read_b64_tr_b16 v[60:61], v11 offset:0
    v_mfma_f32_16x16x32_bf16 v[120:123], v[80:83], v[20:23], v[120:123]
    ds_read_b64_tr_b16 v[62:63], v11 offset:2048
    v_mfma_f32_16x16x32_bf16 v[124:127], v[84:87], v[20:23], v[124:127]
    ds_read_b64_tr_b16 v[64:65], v12 offset:0
    v_mfma_f32_16x16x32_bf16 v[128:131], v[88:91], v[20:23], v[128:131]
    buffer_load_dwordx4 v[20:23], v4, s[60:63], s76 offen offset:1024 sc1
    s_waitcnt vmcnt(13)
    v_mfma_f32_16x16x32_bf16 v[132:135], v[72:75], v[24:27], v[132:135]
    ds_read_b64_tr_b16 v[66:67], v12 offset:2048
    v_mfma_f32_16x16x32_bf16 v[136:139], v[76:79], v[24:27], v[136:139]
    ds_read_b64_tr_b16 v[68:69], v13 offset:4096
    v_mfma_f32_16x16x32_bf16 v[140:143], v[80:83], v[24:27], v[140:143]
    ds_read_b64_tr_b16 v[70:71], v13 offset:4608
    v_mfma_f32_16x16x32_bf16 v[144:147], v[84:87], v[24:27], v[144:147]
    v_mfma_f32_16x16x32_bf16 v[148:151], v[88:91], v[24:27], v[148:151]
    buffer_load_dwordx4 v[24:27], v4, s[60:63], s76 offen offset:2048 sc1
    s_waitcnt vmcnt(13)
    v_mfma_f32_16x16x32_bf16 v[152:155], v[72:75], v[28:31], v[152:155]
    v_mfma_f32_16x16x32_bf16 v[156:159], v[76:79], v[28:31], v[156:159]
    v_mfma_f32_16x16x32_bf16 v[160:163], v[80:83], v[28:31], v[160:163]
    v_mfma_f32_16x16x32_bf16 v[164:167], v[84:87], v[28:31], v[164:167]
    s_waitcnt lgkmcnt(0)
    s_lshl2_add_u32 s75, s6, s72
    s_add_u32 s75, s75, 147456
    v_mfma_f32_16x16x32_bf16 v[168:171], v[88:91], v[28:31], v[168:171]
    buffer_load_dwordx4 v[28:31], v4, s[60:63], s76 offen offset:3072 sc1
    s_waitcnt vmcnt(11)
    v_mfma_f32_16x16x32_bf16 v[172:175], v[72:75], v[32:35], v[172:175]
    s_cmp_eq_u32 s73, 3
    s_cselect_b32 s75, 1073741824, s75
    s_add_u32 m0, s74, 4096
    s_lshr_b32 s85, s75, 12
    s_mul_hi_u32 s85, s85, s97
    s_lshl_b32 s85, s85, 10
    v_mfma_f32_16x16x32_bf16 v[176:179], v[76:79], v[32:35], v[176:179]
    buffer_load_dwordx4 v8, s[60:63], s85 offen sc1 lds
    v_mfma_f32_16x16x32_bf16 v[180:183], v[80:83], v[32:35], v[180:183]
    s_add_u32 m0, s74, 0
    v_mfma_f32_16x16x32_bf16 v[184:187], v[84:87], v[32:35], v[184:187]
    buffer_load_dwordx4 v7, s[48:51], s75 offen lds
    v_mfma_f32_16x16x32_bf16 v[188:191], v[88:91], v[32:35], v[188:191]
    buffer_load_dwordx4 v[32:35], v5, s[60:63], s76 offen sc1
    s_waitcnt vmcnt(12)
    v_mfma_f32_16x16x32_bf16 v[192:195], v[72:75], v[36:39], v[192:195]
    s_add_u32 s75, s75, 9216
    s_add_u32 m0, s74, 1024
    v_mfma_f32_16x16x32_bf16 v[196:199], v[76:79], v[36:39], v[196:199]
    buffer_load_dwordx4 v7, s[48:51], s75 offen lds
    v_mfma_f32_16x16x32_bf16 v[200:203], v[80:83], v[36:39], v[200:203]
    s_add_u32 s75, s75, 9216
    s_add_u32 m0, s74, 2048
    v_mfma_f32_16x16x32_bf16 v[204:207], v[84:87], v[36:39], v[204:207]
    buffer_load_dwordx4 v[36:39], v6, s[60:63], s76 offen offset:0 sc1
    s_waitcnt vmcnt(11)
    v_mfma_f32_16x16x32_bf16 v[208:211], v[72:75], v[40:43], v[208:211]
    buffer_load_dwordx4 v7, s[48:51], s75 offen lds
    v_mfma_f32_16x16x32_bf16 v[212:215], v[76:79], v[40:43], v[212:215]
    s_add_u32 s75, s75, 9216
    s_add_u32 m0, s74, 3072
    v_mfma_f32_16x16x32_bf16 v[216:219], v[80:83], v[40:43], v[216:219]
    buffer_load_dwordx4 v7, s[48:51], s75 offen lds
    v_mfma_f32_16x16x32_bf16 v[220:223], v[84:87], v[40:43], v[220:223]
    buffer_load_dwordx4 v[40:43], v6, s[60:63], s76 offen offset:1024 sc1
    s_waitcnt vmcnt(13)
    v_mfma_f32_16x16x32_bf16 v[224:227], v[72:75], v[44:47], v[224:227]
    v_mfma_f32_16x16x32_bf16 v[228:231], v[76:79], v[44:47], v[228:231]
    v_mfma_f32_16x16x32_bf16 v[232:235], v[80:83], v[44:47], v[232:235]
    v_mfma_f32_16x16x32_bf16 v[236:239], v[84:87], v[44:47], v[236:239]
    buffer_load_dwordx4 v[44:47], v6, s[60:63], s76 offen offset:2048 sc1
    s_waitcnt vmcnt(13)
    v_mfma_f32_16x16x32_bf16 v[240:243], v[72:75], v[48:51], v[240:243]
    v_mfma_f32_16x16x32_bf16 v[244:247], v[76:79], v[48:51], v[244:247]
    v_mfma_f32_16x16x32_bf16 v[248:251], v[80:83], v[48:51], v[248:251]
    v_mfma_f32_16x16x32_bf16 v[252:255], v[84:87], v[48:51], v[252:255]
    buffer_load_dwordx4 v[48:51], v6, s[60:63], s76 offen offset:3072 sc1
    s_waitcnt vmcnt(13)
    v_mfma_f32_16x16x32_bf16 v[92:95], v[52:55], v[16:19], v[92:95]
    s_add_u32 s76, s71, s13
    v_mfma_f32_16x16x32_bf16 v[96:99], v[56:59], v[16:19], v[96:99]
    ds_read_b64_tr_b16 v[72:73], v9 offset:5120
    v_mfma_f32_16x16x32_bf16 v[100:103], v[60:63], v[16:19], v[100:103]
    ds_read_b64_tr_b16 v[74:75], v9 offset:7168
    v_mfma_f32_16x16x32_bf16 v[104:107], v[64:67], v[16:19], v[104:107]
    ds_read_b64_tr_b16 v[76:77], v10 offset:5120
    v_mfma_f32_16x16x32_bf16 v[108:111], v[68:71], v[16:19], v[108:111]
    buffer_load_dwordx4 v[16:19], v4, s[60:63], s76 offen offset:0 sc1
    s_waitcnt vmcnt(13)
    v_mfma_f32_16x16x32_bf16 v[112:115], v[52:55], v[20:23], v[112:115]
    ds_read_b64_tr_b16 v[78:79], v10 offset:7168
    v_mfma_f32_16x16x32_bf16 v[116:119], v[56:59], v[20:23], v[116:119]
    ds_read_b64_tr_b16 v[80:81], v11 offset:5120
    v_mfma_f32_16x16x32_bf16 v[120:123], v[60:63], v[20:23], v[120:123]
    ds_read_b64_tr_b16 v[82:83], v11 offset:7168
    v_mfma_f32_16x16x32_bf16 v[124:127], v[64:67], v[20:23], v[124:127]
    ds_read_b64_tr_b16 v[84:85], v12 offset:5120
    v_mfma_f32_16x16x32_bf16 v[128:131], v[68:71], v[20:23], v[128:131]
    buffer_load_dwordx4 v[20:23], v4, s[60:63], s76 offen offset:1024 sc1
    s_waitcnt vmcnt(13)
    v_mfma_f32_16x16x32_bf16 v[132:135], v[52:55], v[24:27], v[132:135]
    ds_read_b64_tr_b16 v[86:87], v12 offset:7168
    v_mfma_f32_16x16x32_bf16 v[136:139], v[56:59], v[24:27], v[136:139]
    ds_read_b64_tr_b16 v[88:89], v13 offset:9216
    v_mfma_f32_16x16x32_bf16 v[140:143], v[60:63], v[24:27], v[140:143]
    ds_read_b64_tr_b16 v[90:91], v13 offset:9728
    v_mfma_f32_16x16x32_bf16 v[144:147], v[64:67], v[24:27], v[144:147]
    v_mfma_f32_16x16x32_bf16 v[148:151], v[68:71], v[24:27], v[148:151]
    buffer_load_dwordx4 v[24:27], v4, s[60:63], s76 offen offset:2048 sc1
    s_waitcnt vmcnt(13)
    v_mfma_f32_16x16x32_bf16 v[152:155], v[52:55], v[28:31], v[152:155]
    v_mfma_f32_16x16x32_bf16 v[156:159], v[56:59], v[28:31], v[156:159]
    v_mfma_f32_16x16x32_bf16 v[160:163], v[60:63], v[28:31], v[160:163]
    v_mfma_f32_16x16x32_bf16 v[164:167], v[64:67], v[28:31], v[164:167]
    s_waitcnt lgkmcnt(0)
    v_mfma_f32_16x16x32_bf16 v[168:171], v[68:71], v[28:31], v[168:171]
    buffer_load_dwordx4 v[28:31], v4, s[60:63], s76 offen offset:3072 sc1
    s_waitcnt vmcnt(11)
    v_mfma_f32_16x16x32_bf16 v[172:175], v[52:55], v[32:35], v[172:175]
    buffer_load_dword v2, v14, s[60:63], 0 offen sc1
    v_mfma_f32_16x16x32_bf16 v[176:179], v[56:59], v[32:35], v[176:179]
    s_lshl2_add_u32 s75, s7, s72
    s_add_u32 s75, s75, 147456
    s_cmp_eq_u32 s73, 3
    s_cselect_b32 s75, 1073741824, s75
    v_mfma_f32_16x16x32_bf16 v[180:183], v[60:63], v[32:35], v[180:183]
    s_add_u32 m0, s74, 9216
    s_lshr_b32 s85, s75, 12
    s_mul_hi_u32 s85, s85, s97
    s_lshl_b32 s85, s85, 10
    v_mfma_f32_16x16x32_bf16 v[184:187], v[64:67], v[32:35], v[184:187]
    buffer_load_dwordx4 v8, s[60:63], s85 offen sc1 lds
    v_mfma_f32_16x16x32_bf16 v[188:191], v[68:71], v[32:35], v[188:191]
    buffer_load_dwordx4 v[32:35], v5, s[60:63], s76 offen sc1
    s_waitcnt vmcnt(12)
    v_mfma_f32_16x16x32_bf16 v[192:195], v[52:55], v[36:39], v[192:195]
    s_add_u32 m0, s74, 5120
    v_mfma_f32_16x16x32_bf16 v[196:199], v[56:59], v[36:39], v[196:199]
    buffer_load_dwordx4 v7, s[48:51], s75 offen lds
    v_mfma_f32_16x16x32_bf16 v[200:203], v[60:63], v[36:39], v[200:203]
    s_add_u32 s75, s75, 9216
    s_add_u32 m0, s74, 6144
    v_mfma_f32_16x16x32_bf16 v[204:207], v[64:67], v[36:39], v[204:207]
    buffer_load_dwordx4 v[36:39], v6, s[60:63], s76 offen offset:0 sc1
    s_waitcnt vmcnt(11)
    v_mfma_f32_16x16x32_bf16 v[208:211], v[52:55], v[40:43], v[208:211]
    buffer_load_dwordx4 v7, s[48:51], s75 offen lds
    v_mfma_f32_16x16x32_bf16 v[212:215], v[56:59], v[40:43], v[212:215]
    s_add_u32 s75, s75, 9216
    s_add_u32 m0, s74, 7168
    v_mfma_f32_16x16x32_bf16 v[216:219], v[60:63], v[40:43], v[216:219]
    buffer_load_dwordx4 v7, s[48:51], s75 offen lds
    v_mfma_f32_16x16x32_bf16 v[220:223], v[64:67], v[40:43], v[220:223]
    buffer_load_dwordx4 v[40:43], v6, s[60:63], s76 offen offset:1024 sc1
    s_waitcnt vmcnt(13)
    v_mfma_f32_16x16x32_bf16 v[224:227], v[52:55], v[44:47], v[224:227]
    s_add_u32 s75, s75, 9216
    s_add_u32 m0, s74, 8192
    v_mfma_f32_16x16x32_bf16 v[228:231], v[56:59], v[44:47], v[228:231]
    buffer_load_dwordx4 v7, s[48:51], s75 offen lds
    v_mfma_f32_16x16x32_bf16 v[232:235], v[60:63], v[44:47], v[232:235]
    v_mfma_f32_16x16x32_bf16 v[236:239], v[64:67], v[44:47], v[236:239]
    buffer_load_dwordx4 v[44:47], v6, s[60:63], s76 offen offset:2048 sc1
    s_waitcnt vmcnt(14)
    v_mfma_f32_16x16x32_bf16 v[240:243], v[52:55], v[48:51], v[240:243]
    v_mfma_f32_16x16x32_bf16 v[244:247], v[56:59], v[48:51], v[244:247]
    v_mfma_f32_16x16x32_bf16 v[248:251], v[60:63], v[48:51], v[248:251]
    v_mfma_f32_16x16x32_bf16 v[252:255], v[64:67], v[48:51], v[252:255]
    buffer_load_dwordx4 v[48:51], v6, s[60:63], s76 offen offset:3072 sc1
    s_waitcnt vmcnt(14)
    v_mfma_f32_16x16x32_bf16 v[92:95], v[72:75], v[16:19], v[92:95]
    ds_read_b64_tr_b16 v[52:53], v9 offset:0
    v_mfma_f32_16x16x32_bf16 v[96:99], v[76:79], v[16:19], v[96:99]
    ds_read_b64_tr_b16 v[54:55], v9 offset:2048
    v_mfma_f32_16x16x32_bf16 v[100:103], v[80:83], v[16:19], v[100:103]
    ds_read_b64_tr_b16 v[56:57], v10 offset:0
    v_mfma_f32_16x16x32_bf16 v[104:107], v[84:87], v[16:19], v[104:107]
    ds_read_b64_tr_b16 v[58:59], v10 offset:2048
    v_mfma_f32_16x16x32_bf16 v[108:111], v[88:91], v[16:19], v[108:111]
    ds_read_b64_tr_b16 v[60:61], v11 offset:0
    s_waitcnt vmcnt(13)
    v_mfma_f32_16x16x32_bf16 v[112:115], v[72:75], v[20:23], v[112:115]
    ds_read_b64_tr_b16 v[62:63], v11 offset:2048
    v_mfma_f32_16x16x32_bf16 v[116:119], v[76:79], v[20:23], v[116:119]
    ds_read_b64_tr_b16 v[64:65], v12 offset:0
    v_mfma_f32_16x16x32_bf16 v[120:123], v[80:83], v[20:23], v[120:123]
    ds_read_b64_tr_b16 v[66:67], v12 offset:2048
    v_mfma_f32_16x16x32_bf16 v[124:127], v[84:87], v[20:23], v[124:127]
    ds_read_b64_tr_b16 v[68:69], v13 offset:4096
    v_mfma_f32_16x16x32_bf16 v[128:131], v[88:91], v[20:23], v[128:131]
    ds_read_b64_tr_b16 v[70:71], v13 offset:4608
    s_waitcnt vmcnt(12)
    v_mfma_f32_16x16x32_bf16 v[132:135], v[72:75], v[24:27], v[132:135]
    v_mfma_f32_16x16x32_bf16 v[136:139], v[76:79], v[24:27], v[136:139]
    v_mfma_f32_16x16x32_bf16 v[140:143], v[80:83], v[24:27], v[140:143]
    v_mfma_f32_16x16x32_bf16 v[144:147], v[84:87], v[24:27], v[144:147]
    v_mfma_f32_16x16x32_bf16 v[148:151], v[88:91], v[24:27], v[148:151]
    s_waitcnt vmcnt(11)
    v_mfma_f32_16x16x32_bf16 v[152:155], v[72:75], v[28:31], v[152:155]
    v_mfma_f32_16x16x32_bf16 v[156:159], v[76:79], v[28:31], v[156:159]
    v_mfma_f32_16x16x32_bf16 v[160:163], v[80:83], v[28:31], v[160:163]
    v_mfma_f32_16x16x32_bf16 v[164:167], v[84:87], v[28:31], v[164:167]
    s_waitcnt lgkmcnt(0)
    s_lshl2_add_u32 s75, s8, s72
    s_add_u32 s75, s75, 147456
    v_mfma_f32_16x16x32_bf16 v[168:171], v[88:91], v[28:31], v[168:171]
    s_cmp_eq_u32 s73, 3
    s_cselect_b32 s75, 1073741824, s75
    s_add_u32 m0, s74, 4096
    s_lshr_b32 s85, s75, 12
    s_mul_hi_u32 s85, s85, s97
    s_lshl_b32 s85, s85, 10
    s_waitcnt vmcnt(8)
    v_mfma_f32_16x16x32_bf16 v[172:175], v[72:75], v[32:35], v[172:175]
    buffer_load_dwordx4 v8, s[60:63], s85 offen sc1 lds
    v_mfma_f32_16x16x32_bf16 v[176:179], v[76:79], v[32:35], v[176:179]
    s_add_u32 m0, s74, 0
    v_mfma_f32_16x16x32_bf16 v[180:183], v[80:83], v[32:35], v[180:183]
    buffer_load_dwordx4 v7, s[48:51], s75 offen lds
    v_mfma_f32_16x16x32_bf16 v[184:187], v[84:87], v[32:35], v[184:187]
    s_add_u32 s75, s75, 9216
    s_add_u32 m0, s74, 1024
    v_mfma_f32_16x16x32_bf16 v[188:191], v[88:91], v[32:35], v[188:191]
    buffer_load_dwordx4 v7, s[48:51], s75 offen lds
    s_waitcnt vmcnt(9)
    v_mfma_f32_16x16x32_bf16 v[192:195], v[72:75], v[36:39], v[192:195]
    s_add_u32 s75, s75, 9216
    s_add_u32 m0, s74, 2048
    v_mfma_f32_16x16x32_bf16 v[196:199], v[76:79], v[36:39], v[196:199]
    buffer_load_dwordx4 v7, s[48:51], s75 offen lds
    v_mfma_f32_16x16x32_bf16 v[200:203], v[80:83], v[36:39], v[200:203]
    s_add_u32 s75, s75, 9216
    s_add_u32 m0, s74, 3072
    v_mfma_f32_16x16x32_bf16 v[204:207], v[84:87], v[36:39], v[204:207]
    buffer_load_dwordx4 v7, s[48:51], s75 offen lds
    s_waitcnt vmcnt(8)
    v_mfma_f32_16x16x32_bf16 v[208:211], v[72:75], v[40:43], v[208:211]
    v_mfma_f32_16x16x32_bf16 v[212:215], v[76:79], v[40:43], v[212:215]
    v_mfma_f32_16x16x32_bf16 v[216:219], v[80:83], v[40:43], v[216:219]
    v_mfma_f32_16x16x32_bf16 v[220:223], v[84:87], v[40:43], v[220:223]
    s_waitcnt vmcnt(6)
    v_mfma_f32_16x16x32_bf16 v[224:227], v[72:75], v[44:47], v[224:227]
    v_mfma_f32_16x16x32_bf16 v[228:231], v[76:79], v[44:47], v[228:231]
    v_mfma_f32_16x16x32_bf16 v[232:235], v[80:83], v[44:47], v[232:235]
    v_mfma_f32_16x16x32_bf16 v[236:239], v[84:87], v[44:47], v[236:239]
    s_waitcnt vmcnt(5)
    v_mfma_f32_16x16x32_bf16 v[240:243], v[72:75], v[48:51], v[240:243]
    v_mfma_f32_16x16x32_bf16 v[244:247], v[76:79], v[48:51], v[244:247]
    v_mfma_f32_16x16x32_bf16 v[248:251], v[80:83], v[48:51], v[248:251]
    v_mfma_f32_16x16x32_bf16 v[252:255], v[84:87], v[48:51], v[252:255]
L_O_next:
    s_add_u32 s71, s71, 36864
    s_add_u32 s72, s72, 147456
    s_add_u32 s73, s73, 1
    s_cmp_eq_u32 s73, 4
    s_nop 3
    s_cbranch_scc1 L_O_fin
    v_cmp_ge_u32 vcc, s73, v2
    s_cbranch_vccz L_O_go
    s_nop 3
    s_branch L_O_task
L_O_fin:
L_fw_10:
    s_sub_u32 s90, s90, 1
    s_cbranch_scc1 L_bail
    ds_read_b32 v1, v3 offset:0
    s_waitcnt lgkmcnt(0)
    v_cmp_gt_u32 vcc, s73, v1
    s_cbranch_vccnz L_fw_10
    s_waitcnt vmcnt(0) lgkmcnt(0)
    v_lshlrev_b32 v4, 2, v0
    v_add_u32 v4, 161792, v4
    v_mov_b32 v5, 0x7fffffff
    v_lshlrev_b32 v8, 4, v0
    v_and_b32 v1, 15, v0
    v_lshrrev_b32 v2, 4, v0
    v_mul_u32_u24 v9, 2304, v1
    v_lshl_add_u32 v9, v2, 3, v9
    s_mul_i32 s75, s67, 331776
    s_mul_i32 s76, s69, 1152
    s_add_u32 s75, s75, s76
    v_add_u32 v9, s75, v9
    s_mul_i32 s71, s77, 147456
    s_cmp_eq_u32 s77, 0
    s_cselect_b32 s72, 184320, 0
    s_lshl_b32 s82, s68, 7
    s_lshl_b32 s85, s78, 5
    v_add_u32 v10, 65536, v8
    v_add_u32 v11, 131072, v8
    s_cmp_eq_u32 s65, 1
    s_nop 1
    s_cbranch_scc1 L_red1
    s_cmp_eq_u32 s65, 2
    s_nop 1
    s_cbranch_scc1 L_red2
    s_cmp_eq_u32 s65, 3
    s_nop 1
    s_cbranch_scc1 L_red3
L_red0:
    ds_write_b128 v8, v[96:99] offset:0
    ds_write_b128 v8, v[100:103] offset:1024
    ds_write_b128 v8, v[104:107] offset:2048
    ds_write_b128 v8, v[112:115] offset:3072
    ds_write_b128 v8, v[116:119] offset:4096
    ds_write_b128 v8, v[120:123] offset:5120
    ds_write_b128 v8, v[128:131] offset:6144
    ds_write_b128 v8, v[132:135] offset:7168
    ds_write_b128 v8, v[136:139] offset:8192
    ds_write_b128 v8, v[144:147] offset:9216
    ds_write_b128 v8, v[148:151] offset:10240
    ds_write_b128 v8, v[152:155] offset:11264
    ds_write_b128 v8, v[160:163] offset:12288
    ds_write_b128 v8, v[164:167] offset:13312
    ds_write_b128 v8, v[168:171] offset:14336
    ds_write_b128 v8, v[176:179] offset:15360
    ds_write_b128 v10, v[180:183] offset:45056
    ds_write_b128 v10, v[184:187] offset:46080
    ds_write_b128 v10, v[192:195] offset:47104
    ds_write_b128 v10, v[196:199] offset:48128
    ds_write_b128 v10, v[200:203] offset:49152
    ds_write_b128 v10, v[208:211] offset:50176
    ds_write_b128 v10, v[212:215] offset:51200
    ds_write_b128 v10, v[216:219] offset:52224
    ds_write_b128 v10, v[224:227] offset:53248
    ds_write_b128 v10, v[228:231] offset:54272
    ds_write_b128 v10, v[232:235] offset:55296
    ds_write_b128 v10, v[240:243] offset:56320
    ds_write_b128 v10, v[244:247] offset:0
    ds_write_b128 v10, v[248:251] offset:1024
    s_waitcnt lgkmcnt(0)
    s_add_u32 s70, s70, 4
    ds_inc_u32 v4, v5 offset:256
L_fw_11:
    s_sub_u32 s90, s90, 1
    s_cbranch_scc1 L_bail
    ds_read_b32 v7, v4 offset:256
    s_waitcnt lgkmcnt(0)
    v_cmp_gt_u32 vcc, s70, v7
    s_cbranch_vccnz L_fw_11
    ds_read_b128 v[96:99], v8 offset:16384
    ds_read_b128 v[100:103], v8 offset:32768
    ds_read_b128 v[104:107], v8 offset:49152
    ds_read_b128 v[112:115], v8 offset:19456
    ds_read_b128 v[116:119], v8 offset:35840
    ds_read_b128 v[120:123], v8 offset:52224
    ds_read_b128 v[128:131], v8 offset:22528
    ds_read_b128 v[132:135], v8 offset:38912
    ds_read_b128 v[136:139], v8 offset:55296
    ds_read_b128 v[144:147], v8 offset:25600
    ds_read_b128 v[148:151], v8 offset:41984
    ds_read_b128 v[152:155], v8 offset:58368
    ds_read_b128 v[160:163], v8 offset:28672
    ds_read_b128 v[164:167], v8 offset:45056
    ds_read_b128 v[168:171], v8 offset:61440
    ds_read_b128 v[176:179], v8 offset:31744
    ds_read_b128 v[180:183], v8 offset:48128
    ds_read_b128 v[184:187], v8 offset:64512
    ds_read_b128 v[192:195], v10 offset:59392
    ds_read_b128 v[196:199], v11 offset:6144
    ds_read_b128 v[200:203], v11 offset:18432
    ds_read_b128 v[208:211], v10 offset:62464
    ds_read_b128 v[212:215], v11 offset:9216
    ds_read_b128 v[216:219], v11 offset:21504
    ds_read_b128 v[224:227], v11 offset:0
    ds_read_b128 v[228:231], v11 offset:12288
    ds_read_b128 v[232:235], v11 offset:24576
    ds_read_b128 v[240:243], v11 offset:3072
    ds_read_b128 v[244:247], v11 offset:15360
    ds_read_b128 v[248:251], v11 offset:27648
    ds_read_b128 v[16:19], v10 offset:13312
    ds_read_b128 v[20:23], v10 offset:24576
    ds_read_b128 v[24:27], v10 offset:35840
    s_waitcnt lgkmcnt(15)
    v_add_f32 v92, v92, v96
    v_add_f32 v93, v93, v97
    v_add_f32 v94, v94, v98
    v_add_f32 v95, v95, v99
    v_add_f32 v92, v92, v100
    v_add_f32 v93, v93, v101
    v_add_f32 v94, v94, v102
    v_add_f32 v95, v95, v103
    v_add_f32 v92, v92, v104
    v_add_f32 v93, v93, v105
    v_add_f32 v94, v94, v106
    v_add_f32 v95, v95, v107
    v_cvt_pk_bf16_f32 v92, v92, v93
    v_cvt_pk_bf16_f32 v93, v94, v95
    s_add_u32 s75, s71, 0
    s_add_u32 s75, s75, s82
    buffer_store_dwordx2 v[92:93], v9, s[52:55], s75 offen offset:0
    v_add_f32 v108, v108, v112
    v_add_f32 v109, v109, v113
    v_add_f32 v110, v110, v114
    v_add_f32 v111, v111, v115
    v_add_f32 v108, v108, v116
    v_add_f32 v109, v109, v117
    v_add_f32 v110, v110, v118
    v_add_f32 v111, v111, v119
    v_add_f32 v108, v108, v120
    v_add_f32 v109, v109, v121
    v_add_f32 v110, v110, v122
    v_add_f32 v111, v111, v123
    v_cvt_pk_bf16_f32 v108, v108, v109
    v_cvt_pk_bf16_f32 v109, v110, v111
    s_add_u32 s75, s71, 0
    s_add_u32 s75, s75, s85
    s_cmp_eq_u32 s77, 1
    s_cselect_b32 s75, 1073741824, s75
    buffer_store_dwordx2 v[108:109], v9, s[52:55], s75 offen offset:1024
    v_add_f32 v124, v124, v128
    v_add_f32 v125, v125, v129
    v_add_f32 v126, v126, v130
    v_add_f32 v127, v127, v131
    v_add_f32 v124, v124, v132
    v_add_f32 v125, v125, v133
    v_add_f32 v126, v126, v134
    v_add_f32 v127, v127, v135
    v_add_f32 v124, v124, v136
    v_add_f32 v125, v125, v137
    v_add_f32 v126, v126, v138
    v_add_f32 v127, v127, v139
    v_cvt_pk_bf16_f32 v124, v124, v125
    v_cvt_pk_bf16_f32 v125, v126, v127
    s_add_u32 s75, s71, 36864
    s_add_u32 s75, s75, s82
    buffer_store_dwordx2 v[124:125], v9, s[52:55], s75 offen offset:96
    v_add_f32 v140, v140, v144
    v_add_f32 v141, v141, v145
    v_add_f32 v142, v142, v146
    v_add_f32 v143, v143, v147
    v_add_f32 v140, v140, v148
    v_add_f32 v141, v141, v149
    v_add_f32 v142, v142, v150
    v_add_f32 v143, v143, v151
    v_add_f32 v140, v140, v152
    v_add_f32 v141, v141, v153
    v_add_f32 v142, v142, v154
    v_add_f32 v143, v143, v155
    v_cvt_pk_bf16_f32 v140, v140, v141
    v_cvt_pk_bf16_f32 v141, v142, v143
    s_add_u32 s75, s71, 73728
    s_add_u32 s75, s75, s82
    buffer_store_dwordx2 v[140:141], v9, s[52:55], s75 offen offset:64
    v_add_f32 v156, v156, v160
    v_add_f32 v157, v157, v161
    v_add_f32 v158, v158, v162
    v_add_f32 v159, v159, v163
    v_add_f32 v156, v156, v164
    v_add_f32 v157, v157, v165
    v_add_f32 v158, v158, v166
    v_add_f32 v159, v159, v167
    v_add_f32 v156, v156, v168
    v_add_f32 v157, v157, v169
    v_add_f32 v158, v158, v170
    v_add_f32 v159, v159, v171
    v_cvt_pk_bf16_f32 v156, v156, v157
    v_cvt_pk_bf16_f32 v157, v158, v159
    s_add_u32 s75, s71, 110592
    s_add_u32 s75, s75, s82
    buffer_store_dwordx2 v[156:157], v9, s[52:55], s75 offen offset:32
    v_add_f32 v172, v172, v176
    v_add_f32 v173, v173, v177
    v_add_f32 v174, v174, v178
    v_add_f32 v175, v175, v179
    v_add_f32 v172, v172, v180
    v_add_f32 v173, v173, v181
    v_add_f32 v174, v174, v182
    v_add_f32 v175, v175, v183
    v_add_f32 v172, v172, v184
    v_add_f32 v173, v173, v185
    v_add_f32 v174, v174, v186
    v_add_f32 v175, v175, v187
    v_cvt_pk_bf16_f32 v172, v172, v173
    v_cvt_pk_bf16_f32 v173, v174, v175
    s_add_u32 s75, s71, 147456
    s_add_u32 s75, s75, s82
    buffer_store_dwordx2 v[172:173], v9, s[52:55], s75 offen offset:0
    s_waitcnt lgkmcnt(14)
    v_add_f32 v188, v188, v192
    v_add_f32 v189, v189, v193
    v_add_f32 v190, v190, v194
    v_add_f32 v191, v191, v195
    s_waitcnt lgkmcnt(13)
    v_add_f32 v188, v188, v196
    v_add_f32 v189, v189, v197
    v_add_f32 v190, v190, v198
    v_add_f32 v191, v191, v199
    s_waitcnt lgkmcnt(12)
    v_add_f32 v188, v188, v200
    v_add_f32 v189, v189, v201
    v_add_f32 v190, v190, v202
    v_add_f32 v191, v191, v203
    v_cvt_pk_bf16_f32 v188, v188, v189
    v_cvt_pk_bf16_f32 v189, v190, v191
    s_add_u32 s75, s71, 147456
    s_add_u32 s75, s75, s85
    buffer_store_dwordx2 v[188:189], v9, s[52:55], s75 offen offset:1024
    s_waitcnt lgkmcnt(11)
    v_add_f32 v204, v204, v208
    v_add_f32 v205, v205, v209
    v_add_f32 v206, v206, v210
    v_add_f32 v207, v207, v211
    s_waitcnt lgkmcnt(10)
    v_add_f32 v204, v204, v212
    v_add_f32 v205, v205, v213
    v_add_f32 v206, v206, v214
    v_add_f32 v207, v207, v215
    s_waitcnt lgkmcnt(9)
    v_add_f32 v204, v204, v216
    v_add_f32 v205, v205, v217
    v_add_f32 v206, v206, v218
    v_add_f32 v207, v207, v219
    v_cvt_pk_bf16_f32 v204, v204, v205
    v_cvt_pk_bf16_f32 v205, v206, v207
    s_add_u32 s75, s72, 0
    s_add_u32 s75, s75, s82
    buffer_store_dwordx2 v[204:205], v9, s[52:55], s75 offen offset:96
    s_waitcnt lgkmcnt(8)
    v_add_f32 v220, v220, v224
    v_add_f32 v221, v221, v225
    v_add_f32 v222, v222, v226
    v_add_f32 v223, v223, v227
    s_waitcnt lgkmcnt(7)
    v_add_f32 v220, v220, v228
    v_add_f32 v221, v221, v229
    v_add_f32 v222, v222, v230
    v_add_f32 v223, v223, v231
    s_waitcnt lgkmcnt(6)
    v_add_f32 v220, v220, v232
    v_add_f32 v221, v221, v233
    v_add_f32 v222, v222, v234
    v_add_f32 v223, v223, v235
    v_cvt_pk_bf16_f32 v220, v220, v221
    v_cvt_pk_bf16_f32 v221, v222, v223
    s_add_u32 s75, s72, 36864
    s_add_u32 s75, s75, s82
    buffer_store_dwordx2 v[220:221], v9, s[52:55], s75 offen offset:96
    s_waitcnt lgkmcnt(5)
    v_add_f32 v236, v236, v240
    v_add_f32 v237, v237, v241
    v_add_f32 v238, v238, v242
    v_add_f32 v239, v239, v243
    s_waitcnt lgkmcnt(4)
    v_add_f32 v236, v236, v244
    v_add_f32 v237, v237, v245
    v_add_f32 v238, v238, v246
    v_add_f32 v239, v239, v247
    s_waitcnt lgkmcnt(3)
    v_add_f32 v236, v236, v248
    v_add_f32 v237, v237, v249
    v_add_f32 v238, v238, v250
    v_add_f32 v239, v239, v251
    v_cvt_pk_bf16_f32 v236, v236, v237
    v_cvt_pk_bf16_f32 v237, v238, v239
    s_add_u32 s75, s72, 73728
    s_add_u32 s75, s75, s82
    buffer_store_dwordx2 v[236:237], v9, s[52:55], s75 offen offset:96
    s_waitcnt lgkmcnt(2)
    v_add_f32 v252, v252, v16
    v_add_f32 v253, v253, v17
    v_add_f32 v254, v254, v18
    v_add_f32 v255, v255, v19
    s_waitcnt lgkmcnt(1)
    v_add_f32 v252, v252, v20
    v_add_f32 v253, v253, v21
    v_add_f32 v254, v254, v22
    v_add_f32 v255, v255, v23
    s_waitcnt lgkmcnt(0)
    v_add_f32 v252, v252, v24
    v_add_f32 v253, v253, v25
    v_add_f32 v254, v254, v26
    v_add_f32 v255, v255, v27
    v_cvt_pk_bf16_f32 v252, v252, v253
    v_cvt_pk_bf16_f32 v253, v254, v255
    s_add_u32 s75, s72, 110592
    s_add_u32 s75, s75, s82
    buffer_store_dwordx2 v[252:253], v9, s[52:55], s75 offen offset:96
    s_nop 1
    s_branch L_bail
L_red1:
    ds_write_b128 v8, v[92:95] offset:16384
    ds_write_b128 v8, v[100:103] offset:17408
    ds_write_b128 v8, v[104:107] offset:18432
    ds_write_b128 v8, v[108:111] offset:19456
    ds_write_b128 v8, v[116:119] offset:20480
    ds_write_b128 v8, v[120:123] offset:21504
    ds_write_b128 v8, v[124:127] offset:22528
    ds_write_b128 v8, v[132:135] offset:23552
    ds_write_b128 v8, v[136:139] offset:24576
    ds_write_b128 v8, v[140:143] offset:25600
    ds_write_b128 v8, v[148:151] offset:26624
    ds_write_b128 v8, v[152:155] offset:27648
    ds_write_b128 v8, v[156:159] offset:28672
    ds_write_b128 v8, v[164:167] offset:29696
    ds_write_b128 v8, v[168:171] offset:30720
    ds_write_b128 v8, v[172:175] offset:31744
    ds_write_b128 v10, v[180:183] offset:57344
    ds_write_b128 v10, v[184:187] offset:58368
    ds_write_b128 v10, v[188:191] offset:59392
    ds_write_b128 v10, v[196:199] offset:60416
    ds_write_b128 v10, v[200:203] offset:61440
    ds_write_b128 v10, v[204:207] offset:62464
    ds_write_b128 v10, v[212:215] offset:63488
    ds_write_b128 v10, v[216:219] offset:64512
    ds_write_b128 v11, v[220:223] offset:0
    ds_write_b128 v11, v[228:231] offset:1024
    ds_write_b128 v11, v[232:235] offset:2048
    ds_write_b128 v11, v[236:239] offset:3072
    ds_write_b128 v10, v[244:247] offset:11264
    ds_write_b128 v10, v[248:251] offset:12288
    ds_write_b128 v10, v[252:255] offset:13312
    s_waitcnt lgkmcnt(0)
    s_add_u32 s70, s70, 4
    ds_inc_u32 v4, v5 offset:256
L_fw_12:
    s_sub_u32 s90, s90, 1
    s_cbranch_scc1 L_bail
    ds_read_b32 v7, v4 offset:256
    s_waitcnt lgkmcnt(0)
    v_cmp_gt_u32 vcc, s70, v7
    s_cbranch_vccnz L_fw_12
    ds_read_b128 v[92:95], v8 offset:0
    ds_read_b128 v[100:103], v8 offset:33792
    ds_read_b128 v[104:107], v8 offset:50176
    ds_read_b128 v[108:111], v8 offset:3072
    ds_read_b128 v[116:119], v8 offset:36864
    ds_read_b128 v[120:123], v8 offset:53248
    ds_read_b128 v[124:127], v8 offset:6144
    ds_read_b128 v[132:135], v8 offset:39936
    ds_read_b128 v[136:139], v8 offset:56320
    ds_read_b128 v[140:143], v8 offset:9216
    ds_read_b128 v[148:151], v8 offset:43008
    ds_read_b128 v[152:155], v8 offset:59392
    ds_read_b128 v[156:159], v8 offset:12288
    ds_read_b128 v[164:167], v8 offset:46080
    ds_read_b128 v[168:171], v8 offset:62464
    ds_read_b128 v[172:175], v8 offset:15360
    ds_read_b128 v[180:183], v11 offset:4096
    ds_read_b128 v[184:187], v11 offset:16384
    ds_read_b128 v[188:191], v10 offset:47104
    ds_read_b128 v[196:199], v11 offset:7168
    ds_read_b128 v[200:203], v11 offset:19456
    ds_read_b128 v[204:207], v10 offset:50176
    ds_read_b128 v[212:215], v11 offset:10240
    ds_read_b128 v[216:219], v11 offset:22528
    ds_read_b128 v[220:223], v10 offset:53248
    ds_read_b128 v[228:231], v11 offset:13312
    ds_read_b128 v[232:235], v11 offset:25600
    ds_read_b128 v[236:239], v10 offset:56320
    ds_read_b128 v[244:247], v10 offset:22528
    ds_read_b128 v[248:251], v10 offset:33792
    s_waitcnt lgkmcnt(15)
    v_add_f32 v96, v96, v92
    v_add_f32 v97, v97, v93
    v_add_f32 v98, v98, v94
    v_add_f32 v99, v99, v95
    v_add_f32 v96, v96, v100
    v_add_f32 v97, v97, v101
    v_add_f32 v98, v98, v102
    v_add_f32 v99, v99, v103
    v_add_f32 v96, v96, v104
    v_add_f32 v97, v97, v105
    v_add_f32 v98, v98, v106
    v_add_f32 v99, v99, v107
    v_cvt_pk_bf16_f32 v96, v96, v97
    v_cvt_pk_bf16_f32 v97, v98, v99
    s_add_u32 s75, s71, 0
    s_add_u32 s75, s75, s82
    buffer_store_dwordx2 v[96:97], v9, s[52:55], s75 offen offset:32
    v_add_f32 v112, v112, v108
    v_add_f32 v113, v113, v109
    v_add_f32 v114, v114, v110
    v_add_f32 v115, v115, v111
    v_add_f32 v112, v112, v116
    v_add_f32 v113, v113, v117
    v_add_f32 v114, v114, v118
    v_add_f32 v115, v115, v119
    v_add_f32 v112, v112, v120
    v_add_f32 v113, v113, v121
    v_add_f32 v114, v114, v122
    v_add_f32 v115, v115, v123
    v_cvt_pk_bf16_f32 v112, v112, v113
    v_cvt_pk_bf16_f32 v113, v114, v115
    s_add_u32 s75, s71, 36864
    s_add_u32 s75, s75, s82
    buffer_store_dwordx2 v[112:113], v9, s[52:55], s75 offen offset:0
    v_add_f32 v128, v128, v124
    v_add_f32 v129, v129, v125
    v_add_f32 v130, v130, v126
    v_add_f32 v131, v131, v127
    v_add_f32 v128, v128, v132
    v_add_f32 v129, v129, v133
    v_add_f32 v130, v130, v134
    v_add_f32 v131, v131, v135
    v_add_f32 v128, v128, v136
    v_add_f32 v129, v129, v137
    v_add_f32 v130, v130, v138
    v_add_f32 v131, v131, v139
    v_cvt_pk_bf16_f32 v128, v128, v129
    v_cvt_pk_bf16_f32 v129, v130, v131
    s_add_u32 s75, s71, 36864
    s_add_u32 s75, s75, s85
    buffer_store_dwordx2 v[128:129], v9, s[52:55], s75 offen offset:1024
    v_add_f32 v144, v144, v140
    v_add_f32 v145, v145, v141
    v_add_f32 v146, v146, v142
    v_add_f32 v147, v147, v143
    v_add_f32 v144, v144, v148
    v_add_f32 v145, v145, v149
    v_add_f32 v146, v146, v150
    v_add_f32 v147, v147, v151
    v_add_f32 v144, v144, v152
    v_add_f32 v145, v145, v153
    v_add_f32 v146, v146, v154
    v_add_f32 v147, v147, v155
    v_cvt_pk_bf16_f32 v144, v144, v145
    v_cvt_pk_bf16_f32 v145, v146, v147
    s_add_u32 s75, s71, 73728
    s_add_u32 s75, s75, s82
    buffer_store_dwordx2 v[144:145], v9, s[52:55], s75 offen offset:96
    v_add_f32 v160, v160, v156
    v_add_f32 v161, v161, v157
    v_add_f32 v162, v162, v158
    v_add_f32 v163, v163, v159
    v_add_f32 v160, v160, v164
    v_add_f32 v161, v161, v165
    v_add_f32 v162, v162, v166
    v_add_f32 v163, v163, v167
    v_add_f32 v160, v160, v168
    v_add_f32 v161, v161, v169
    v_add_f32 v162, v162, v170
    v_add_f32 v163, v163, v171
    v_cvt_pk_bf16_f32 v160, v160, v161
    v_cvt_pk_bf16_f32 v161, v162, v163
    s_add_u32 s75, s71, 110592
    s_add_u32 s75, s75, s82
    buffer_store_dwordx2 v[160:161], v9, s[52:55], s75 offen offset:64
    s_waitcnt lgkmcnt(14)
    v_add_f32 v176, v176, v172
    v_add_f32 v177, v177, v173
    v_add_f32 v178, v178, v174
    v_add_f32 v179, v179, v175
    s_waitcnt lgkmcnt(13)
    v_add_f32 v176, v176, v180
    v_add_f32 v177, v177, v181
    v_add_f32 v178, v178, v182
    v_add_f32 v179, v179, v183
    s_waitcnt lgkmcnt(12)
    v_add_f32 v176, v176, v184
    v_add_f32 v177, v177, v185
    v_add_f32 v178, v178, v186
    v_add_f32 v179, v179, v187
    v_cvt_pk_bf16_f32 v176, v176, v177
    v_cvt_pk_bf16_f32 v177, v178, v179
    s_add_u32 s75, s71, 147456
    s_add_u32 s75, s75, s82
    buffer_store_dwordx2 v[176:177], v9, s[52:55], s75 offen offset:32
    s_waitcnt lgkmcnt(11)
    v_add_f32 v192, v192, v188
    v_add_f32 v193, v193, v189
    v_add_f32 v194, v194, v190
    v_add_f32 v195, v195, v191
    s_waitcnt lgkmcnt(10)
    v_add_f32 v192, v192, v196
    v_add_f32 v193, v193, v197
    v_add_f32 v194, v194, v198
    v_add_f32 v195, v195, v199
    s_waitcnt lgkmcnt(9)
    v_add_f32 v192, v192, v200
    v_add_f32 v193, v193, v201
    v_add_f32 v194, v194, v202
    v_add_f32 v195, v195, v203
    v_cvt_pk_bf16_f32 v192, v192, v193
    v_cvt_pk_bf16_f32 v193, v194, v195
    s_add_u32 s75, s72, 0
    s_add_u32 s75, s75, s82
    buffer_store_dwordx2 v[192:193], v9, s[52:55], s75 offen offset:0
    s_waitcnt lgkmcnt(8)
    v_add_f32 v208, v208, v204
    v_add_f32 v209, v209, v205
    v_add_f32 v210, v210, v206
    v_add_f32 v211, v211, v207
    s_waitcnt lgkmcnt(7)
    v_add_f32 v208, v208, v212
    v_add_f32 v209, v209, v213
    v_add_f32 v210, v210, v214
    v_add_f32 v211, v211, v215
    s_waitcnt lgkmcnt(6)
    v_add_f32 v208, v208, v216
    v_add_f32 v209, v209, v217
    v_add_f32 v210, v210, v218
    v_add_f32 v211, v211, v219
    v_cvt_pk_bf16_f32 v208, v208, v209
    v_cvt_pk_bf16_f32 v209, v210, v211
    s_add_u32 s75, s72, 36864
    s_add_u32 s75, s75, s82
    buffer_store_dwordx2 v[208:209], v9, s[52:55], s75 offen offset:0
    s_waitcnt lgkmcnt(5)
    v_add_f32 v224, v224, v220
    v_add_f32 v225, v225, v221
    v_add_f32 v226, v226, v222
    v_add_f32 v227, v227, v223
    s_waitcnt lgkmcnt(4)
    v_add_f32 v224, v224, v228
    v_add_f32 v225, v225, v229
    v_add_f32 v226, v226, v230
    v_add_f32 v227, v227, v231
    s_waitcnt lgkmcnt(3)
    v_add_f32 v224, v224, v232
    v_add_f32 v225, v225, v233
    v_add_f32 v226, v226, v234
    v_add_f32 v227, v227, v235
    v_cvt_pk_bf16_f32 v224, v224, v225
    v_cvt_pk_bf16_f32 v225, v226, v227
    s_add_u32 s75, s72, 73728
    s_add_u32 s75, s75, s82
    buffer_store_dwordx2 v[224:225], v9, s[52:55], s75 offen offset:0
    s_waitcnt lgkmcnt(2)
    v_add_f32 v240, v240, v236
    v_add_f32 v241, v241, v237
    v_add_f32 v242, v242, v238
    v_add_f32 v243, v243, v239
    s_waitcnt lgkmcnt(1)
    v_add_f32 v240, v240, v244
    v_add_f32 v241, v241, v245
    v_add_f32 v242, v242, v246
    v_add_f32 v243, v243, v247
    s_waitcnt lgkmcnt(0)
    v_add_f32 v240, v240, v248
    v_add_f32 v241, v241, v249
    v_add_f32 v242, v242, v250
    v_add_f32 v243, v243, v251
    v_cvt_pk_bf16_f32 v240, v240, v241
    v_cvt_pk_bf16_f32 v241, v242, v243
    s_add_u32 s75, s72, 110592
    s_add_u32 s75, s75, s82
    buffer_store_dwordx2 v[240:241], v9, s[52:55], s75 offen offset:0
    s_nop 1
    s_branch L_bail
L_red2:
    ds_write_b128 v8, v[92:95] offset:32768
    ds_write_b128 v8, v[96:99] offset:33792
    ds_write_b128 v8, v[104:107] offset:34816
    ds_write_b128 v8, v[108:111] offset:35840
    ds_write_b128 v8, v[112:115] offset:36864
    ds_write_b128 v8, v[120:123] offset:37888
    ds_write_b128 v8, v[124:127] offset:38912
    ds_write_b128 v8, v[128:131] offset:39936
    ds_write_b128 v8, v[136:139] offset:40960
    ds_write_b128 v8, v[140:143] offset:41984
    ds_write_b128 v8, v[144:147] offset:43008
    ds_write_b128 v8, v[152:155] offset:44032
    ds_write_b128 v8, v[156:159] offset:45056
    ds_write_b128 v8, v[160:163] offset:46080
    ds_write_b128 v8, v[168:171] offset:47104
    ds_write_b128 v8, v[172:175] offset:48128
    ds_write_b128 v11, v[176:179] offset:4096
    ds_write_b128 v11, v[184:187] offset:5120
    ds_write_b128 v11, v[188:191] offset:6144
    ds_write_b128 v11, v[192:195] offset:7168
    ds_write_b128 v11, v[200:203] offset:8192
    ds_write_b128 v11, v[204:207] offset:9216
    ds_write_b128 v11, v[208:211] offset:10240
    ds_write_b128 v11, v[216:219] offset:11264
    ds_write_b128 v11, v[220:223] offset:12288
    ds_write_b128 v11, v[224:227] offset:13312
    ds_write_b128 v11, v[232:235] offset:14336
    ds_write_b128 v11, v[236:239] offset:15360
    ds_write_b128 v10, v[240:243] offset:22528
    ds_write_b128 v10, v[248:251] offset:23552
    ds_write_b128 v10, v[252:255] offset:24576
    s_waitcnt lgkmcnt(0)
    s_add_u32 s70, s70, 4
    ds_inc_u32 v4, v5 offset:256
L_fw_13:
    s_sub_u32 s90, s90, 1
    s_cbranch_scc1 L_bail
    ds_read_b32 v7, v4 offset:256
    s_waitcnt lgkmcnt(0)
    v_cmp_gt_u32 vcc, s70, v7
    s_cbranch_vccnz L_fw_13
    ds_read_b128 v[92:95], v8 offset:1024
    ds_read_b128 v[96:99], v8 offset:17408
    ds_read_b128 v[104:107], v8 offset:51200
    ds_read_b128 v[108:111], v8 offset:4096
    ds_read_b128 v[112:115], v8 offset:20480
    ds_read_b128 v[120:123], v8 offset:54272
    ds_read_b128 v[124:127], v8 offset:7168
    ds_read_b128 v[128:131], v8 offset:23552
    ds_read_b128 v[136:139], v8 offset:57344
    ds_read_b128 v[140:143], v8 offset:10240
    ds_read_b128 v[144:147], v8 offset:26624
    ds_read_b128 v[152:155], v8 offset:60416
    ds_read_b128 v[156:159], v8 offset:13312
    ds_read_b128 v[160:163], v8 offset:29696
    ds_read_b128 v[168:171], v8 offset:63488
    ds_read_b128 v[172:175], v10 offset:45056
    ds_read_b128 v[176:179], v10 offset:57344
    ds_read_b128 v[184:187], v11 offset:17408
    ds_read_b128 v[188:191], v10 offset:48128
    ds_read_b128 v[192:195], v10 offset:60416
    ds_read_b128 v[200:203], v11 offset:20480
    ds_read_b128 v[204:207], v10 offset:51200
    ds_read_b128 v[208:211], v10 offset:63488
    ds_read_b128 v[216:219], v11 offset:23552
    ds_read_b128 v[220:223], v10 offset:54272
    ds_read_b128 v[224:227], v11 offset:1024
    ds_read_b128 v[232:235], v11 offset:26624
    ds_read_b128 v[236:239], v10 offset:0
    ds_read_b128 v[240:243], v10 offset:11264
    ds_read_b128 v[248:251], v10 offset:34816
    s_waitcnt lgkmcnt(15)
    v_add_f32 v100, v100, v92
    v_add_f32 v101, v101, v93
    v_add_f32 v102, v102, v94
    v_add_f32 v103, v103, v95
    v_add_f32 v100, v100, v96
    v_add_f32 v101, v101, v97
    v_add_f32 v102, v102, v98
    v_add_f32 v103, v103, v99
    v_add_f32 v100, v100, v104
    v_add_f32 v101, v101, v105
    v_add_f32 v102, v102, v106
    v_add_f32 v103, v103, v107
    v_cvt_pk_bf16_f32 v100, v100, v101
    v_cvt_pk_bf16_f32 v101, v102, v103
    s_add_u32 s75, s71, 0
    s_add_u32 s75, s75, s82
    buffer_store_dwordx2 v[100:101], v9, s[52:55], s75 offen offset:64
    v_add_f32 v116, v116, v108
    v_add_f32 v117, v117, v109
    v_add_f32 v118, v118, v110
    v_add_f32 v119, v119, v111
    v_add_f32 v116, v116, v112
    v_add_f32 v117, v117, v113
    v_add_f32 v118, v118, v114
    v_add_f32 v119, v119, v115
    v_add_f32 v116, v116, v120
    v_add_f32 v117, v117, v121
    v_add_f32 v118, v118, v122
    v_add_f32 v119, v119, v123
    v_cvt_pk_bf16_f32 v116, v116, v117
    v_cvt_pk_bf16_f32 v117, v118, v119
    s_add_u32 s75, s71, 36864
    s_add_u32 s75, s75, s82
    buffer_store_dwordx2 v[116:117], v9, s[52:55], s75 offen offset:32
    v_add_f32 v132, v132, v124
    v_add_f32 v133, v133, v125
    v_add_f32 v134, v134, v126
    v_add_f32 v135, v135, v127
    v_add_f32 v132, v132, v128
    v_add_f32 v133, v133, v129
    v_add_f32 v134, v134, v130
    v_add_f32 v135, v135, v131
    v_add_f32 v132, v132, v136
    v_add_f32 v133, v133, v137
    v_add_f32 v134, v134, v138
    v_add_f32 v135, v135, v139
    v_cvt_pk_bf16_f32 v132, v132, v133
    v_cvt_pk_bf16_f32 v133, v134, v135
    s_add_u32 s75, s71, 73728
    s_add_u32 s75, s75, s82
    buffer_store_dwordx2 v[132:133], v9, s[52:55], s75 offen offset:0
    v_add_f32 v148, v148, v140
    v_add_f32 v149, v149, v141
    v_add_f32 v150, v150, v142
    v_add_f32 v151, v151, v143
    v_add_f32 v148, v148, v144
    v_add_f32 v149, v149, v145
    v_add_f32 v150, v150, v146
    v_add_f32 v151, v151, v147
    v_add_f32 v148, v148, v152
    v_add_f32 v149, v149, v153
    v_add_f32 v150, v150, v154
    v_add_f32 v151, v151, v155
    v_cvt_pk_bf16_f32 v148, v148, v149
    v_cvt_pk_bf16_f32 v149, v150, v151
    s_add_u32 s75, s71, 73728
    s_add_u32 s75, s75, s85
    buffer_store_dwordx2 v[148:149], v9, s[52:55], s75 offen offset:1024
    v_add_f32 v164, v164, v156
    v_add_f32 v165, v165, v157
    v_add_f32 v166, v166, v158
    v_add_f32 v167, v167, v159
    v_add_f32 v164, v164, v160
    v_add_f32 v165, v165, v161
    v_add_f32 v166, v166, v162
    v_add_f32 v167, v167, v163
    v_add_f32 v164, v164, v168
    v_add_f32 v165, v165, v169
    v_add_f32 v166, v166, v170
    v_add_f32 v167, v167, v171
    v_cvt_pk_bf16_f32 v164, v164, v165
    v_cvt_pk_bf16_f32 v165, v166, v167
    s_add_u32 s75, s71, 110592
    s_add_u32 s75, s75, s82
    buffer_store_dwordx2 v[164:165], v9, s[52:55], s75 offen offset:96
    s_waitcnt lgkmcnt(14)
    v_add_f32 v180, v180, v172
    v_add_f32 v181, v181, v173
    v_add_f32 v182, v182, v174
    v_add_f32 v183, v183, v175
    s_waitcnt lgkmcnt(13)
    v_add_f32 v180, v180, v176
    v_add_f32 v181, v181, v177
    v_add_f32 v182, v182, v178
    v_add_f32 v183, v183, v179
    s_waitcnt lgkmcnt(12)
    v_add_f32 v180, v180, v184
    v_add_f32 v181, v181, v185
    v_add_f32 v182, v182, v186
    v_add_f32 v183, v183, v187
    v_cvt_pk_bf16_f32 v180, v180, v181
    v_cvt_pk_bf16_f32 v181, v182, v183
    s_add_u32 s75, s71, 147456
    s_add_u32 s75, s75, s82
    buffer_store_dwordx2 v[180:181], v9, s[52:55], s75 offen offset:64
    s_waitcnt lgkmcnt(11)
    v_add_f32 v196, v196, v188
    v_add_f32 v197, v197, v189
    v_add_f32 v198, v198, v190
    v_add_f32 v199, v199, v191
    s_waitcnt lgkmcnt(10)
    v_add_f32 v196, v196, v192
    v_add_f32 v197, v197, v193
    v_add_f32 v198, v198, v194
    v_add_f32 v199, v199, v195
    s_waitcnt lgkmcnt(9)
    v_add_f32 v196, v196, v200
    v_add_f32 v197, v197, v201
    v_add_f32 v198, v198, v202
    v_add_f32 v199, v199, v203
    v_cvt_pk_bf16_f32 v196, v196, v197
    v_cvt_pk_bf16_f32 v197, v198, v199
    s_add_u32 s75, s72, 0
    s_add_u32 s75, s75, s82
    buffer_store_dwordx2 v[196:197], v9, s[52:55], s75 offen offset:32
    s_waitcnt lgkmcnt(8)
    v_add_f32 v212, v212, v204
    v_add_f32 v213, v213, v205
    v_add_f32 v214, v214, v206
    v_add_f32 v215, v215, v207
    s_waitcnt lgkmcnt(7)
    v_add_f32 v212, v212, v208
    v_add_f32 v213, v213, v209
    v_add_f32 v214, v214, v210
    v_add_f32 v215, v215, v211
    s_waitcnt lgkmcnt(6)
    v_add_f32 v212, v212, v216
    v_add_f32 v213, v213, v217
    v_add_f32 v214, v214, v218
    v_add_f32 v215, v215, v219
    v_cvt_pk_bf16_f32 v212, v212, v213
    v_cvt_pk_bf16_f32 v213, v214, v215
    s_add_u32 s75, s72, 36864
    s_add_u32 s75, s75, s82
    buffer_store_dwordx2 v[212:213], v9, s[52:55], s75 offen offset:32
    s_waitcnt lgkmcnt(5)
    v_add_f32 v228, v228, v220
    v_add_f32 v229, v229, v221
    v_add_f32 v230, v230, v222
    v_add_f32 v231, v231, v223
    s_waitcnt lgkmcnt(4)
    v_add_f32 v228, v228, v224
    v_add_f32 v229, v229, v225
    v_add_f32 v230, v230, v226
    v_add_f32 v231, v231, v227
    s_waitcnt lgkmcnt(3)
    v_add_f32 v228, v228, v232
    v_add_f32 v229, v229, v233
    v_add_f32 v230, v230, v234
    v_add_f32 v231, v231, v235
    v_cvt_pk_bf16_f32 v228, v228, v229
    v_cvt_pk_bf16_f32 v229, v230, v231
    s_add_u32 s75, s72, 73728
    s_add_u32 s75, s75, s82
    buffer_store_dwordx2 v[228:229], v9, s[52:55], s75 offen offset:32
    s_waitcnt lgkmcnt(2)
    v_add_f32 v244, v244, v236
    v_add_f32 v245, v245, v237
    v_add_f32 v246, v246, v238
    v_add_f32 v247, v247, v239
    s_waitcnt lgkmcnt(1)
    v_add_f32 v244, v244, v240
    v_add_f32 v245, v245, v241
    v_add_f32 v246, v246, v242
    v_add_f32 v247, v247, v243
    s_waitcnt lgkmcnt(0)
    v_add_f32 v244, v244, v248
    v_add_f32 v245, v245, v249
    v_add_f32 v246, v246, v250
    v_add_f32 v247, v247, v251
    v_cvt_pk_bf16_f32 v244, v244, v245
    v_cvt_pk_bf16_f32 v245, v246, v247
    s_add_u32 s75, s72, 110592
    s_add_u32 s75, s75, s82
    buffer_store_dwordx2 v[244:245], v9, s[52:55], s75 offen offset:32
    s_nop 1
    s_branch L_bail
L_red3:
    ds_write_b128 v8, v[92:95] offset:49152
    ds_write_b128 v8, v[96:99] offset:50176
    ds_write_b128 v8, v[100:103] offset:51200
    ds_write_b128 v8, v[108:111] offset:52224
    ds_write_b128 v8, v[112:115] offset:53248
    ds_write_b128 v8, v[116:119] offset:54272
    ds_write_b128 v8, v[124:127] offset:55296
    ds_write_b128 v8, v[128:131] offset:56320
    ds_write_b128 v8, v[132:135] offset:57344
    ds_write_b128 v8, v[140:143] offset:58368
    ds_write_b128 v8, v[144:147] offset:59392
    ds_write_b128 v8, v[148:151] offset:60416
    ds_write_b128 v8, v[156:159] offset:61440
    ds_write_b128 v8, v[160:163] offset:62464
    ds_write_b128 v8, v[164:167] offset:63488
    ds_write_b128 v8, v[172:175] offset:64512
    ds_write_b128 v11, v[176:179] offset:16384
    ds_write_b128 v11, v[180:183] offset:17408
    ds_write_b128 v11, v[188:191] offset:18432
    ds_write_b128 v11, v[192:195] offset:19456
    ds_write_b128 v11, v[196:199] offset:20480
    ds_write_b128 v11, v[204:207] offset:21504
    ds_write_b128 v11, v[208:211] offset:22528
    ds_write_b128 v11, v[212:215] offset:23552
    ds_write_b128 v11, v[220:223] offset:24576
    ds_write_b128 v11, v[224:227] offset:25600
    ds_write_b128 v11, v[228:231] offset:26624
    ds_write_b128 v11, v[236:239] offset:27648
    ds_write_b128 v10, v[240:243] offset:33792
    ds_write_b128 v10, v[244:247] offset:34816
    ds_write_b128 v10, v[252:255] offset:35840
    s_waitcnt lgkmcnt(0)
    s_add_u32 s70, s70, 4
    ds_inc_u32 v4, v5 offset:256
L_fw_14:
    s_sub_u32 s90, s90, 1
    s_cbranch_scc1 L_bail
    ds_read_b32 v7, v4 offset:256
    s_waitcnt lgkmcnt(0)
    v_cmp_gt_u32 vcc, s70, v7
    s_cbranch_vccnz L_fw_14
    ds_read_b128 v[92:95], v8 offset:2048
    ds_read_b128 v[96:99], v8 offset:18432
    ds_read_b128 v[100:103], v8 offset:34816
    ds_read_b128 v[108:111], v8 offset:5120
    ds_read_b128 v[112:115], v8 offset:21504
    ds_read_b128 v[116:119], v8 offset:37888
    ds_read_b128 v[124:127], v8 offset:8192
    ds_read_b128 v[128:131], v8 offset:24576
    ds_read_b128 v[132:135], v8 offset:40960
    ds_read_b128 v[140:143], v8 offset:11264
    ds_read_b128 v[144:147], v8 offset:27648
    ds_read_b128 v[148:151], v8 offset:44032
    ds_read_b128 v[156:159], v8 offset:14336
    ds_read_b128 v[160:163], v8 offset:30720
    ds_read_b128 v[164:167], v8 offset:47104
    ds_read_b128 v[172:175], v10 offset:46080
    ds_read_b128 v[176:179], v10 offset:58368
    ds_read_b128 v[180:183], v11 offset:5120
    ds_read_b128 v[188:191], v10 offset:49152
    ds_read_b128 v[192:195], v10 offset:61440
    ds_read_b128 v[196:199], v11 offset:8192
    ds_read_b128 v[204:207], v10 offset:52224
    ds_read_b128 v[208:211], v10 offset:64512
    ds_read_b128 v[212:215], v11 offset:11264
    ds_read_b128 v[220:223], v10 offset:55296
    ds_read_b128 v[224:227], v11 offset:2048
    ds_read_b128 v[228:231], v11 offset:14336
    ds_read_b128 v[236:239], v10 offset:1024
    ds_read_b128 v[240:243], v10 offset:12288
    ds_read_b128 v[244:247], v10 offset:23552
    s_waitcnt lgkmcnt(15)
    v_add_f32 v104, v104, v92
    v_add_f32 v105, v105, v93
    v_add_f32 v106, v106, v94
    v_add_f32 v107, v107, v95
    v_add_f32 v104, v104, v96
    v_add_f32 v105, v105, v97
    v_add_f32 v106, v106, v98
    v_add_f32 v107, v107, v99
    v_add_f32 v104, v104, v100
    v_add_f32 v105, v105, v101
    v_add_f32 v106, v106, v102
    v_add_f32 v107, v107, v103
    v_cvt_pk_bf16_f32 v104, v104, v105
    v_cvt_pk_bf16_f32 v105, v106, v107
    s_add_u32 s75, s71, 0
    s_add_u32 s75, s75, s82
    buffer_store_dwordx2 v[104:105], v9, s[52:55], s75 offen offset:96
    v_add_f32 v120, v120, v108
    v_add_f32 v121, v121, v109
    v_add_f32 v122, v122, v110
    v_add_f32 v123, v123, v111
    v_add_f32 v120, v120, v112
    v_add_f32 v121, v121, v113
    v_add_f32 v122, v122, v114
    v_add_f32 v123, v123, v115
    v_add_f32 v120, v120, v116
    v_add_f32 v121, v121, v117
    v_add_f32 v122, v122, v118
    v_add_f32 v123, v123, v119
    v_cvt_pk_bf16_f32 v120, v120, v121
    v_cvt_pk_bf16_f32 v121, v122, v123
    s_add_u32 s75, s71, 36864
    s_add_u32 s75, s75, s82
    buffer_store_dwordx2 v[120:121], v9, s[52:55], s75 offen offset:64
    v_add_f32 v136, v136, v124
    v_add_f32 v137, v137, v125
    v_add_f32 v138, v138, v126
    v_add_f32 v139, v139, v127
    v_add_f32 v136, v136, v128
    v_add_f32 v137, v137, v129
    v_add_f32 v138, v138, v130
    v_add_f32 v139, v139, v131
    v_add_f32 v136, v136, v132
    v_add_f32 v137, v137, v133
    v_add_f32 v138, v138, v134
    v_add_f32 v139, v139, v135
    v_cvt_pk_bf16_f32 v136, v136, v137
    v_cvt_pk_bf16_f32 v137, v138, v139
    s_add_u32 s75, s71, 73728
    s_add_u32 s75, s75, s82
    buffer_store_dwordx2 v[136:137], v9, s[52:55], s75 offen offset:32
    v_add_f32 v152, v152, v140
    v_add_f32 v153, v153, v141
    v_add_f32 v154, v154, v142
    v_add_f32 v155, v155, v143
    v_add_f32 v152, v152, v144
    v_add_f32 v153, v153, v145
    v_add_f32 v154, v154, v146
    v_add_f32 v155, v155, v147
    v_add_f32 v152, v152, v148
    v_add_f32 v153, v153, v149
    v_add_f32 v154, v154, v150
    v_add_f32 v155, v155, v151
    v_cvt_pk_bf16_f32 v152, v152, v153
    v_cvt_pk_bf16_f32 v153, v154, v155
    s_add_u32 s75, s71, 110592
    s_add_u32 s75, s75, s82
    buffer_store_dwordx2 v[152:153], v9, s[52:55], s75 offen offset:0
    v_add_f32 v168, v168, v156
    v_add_f32 v169, v169, v157
    v_add_f32 v170, v170, v158
    v_add_f32 v171, v171, v159
    v_add_f32 v168, v168, v160
    v_add_f32 v169, v169, v161
    v_add_f32 v170, v170, v162
    v_add_f32 v171, v171, v163
    v_add_f32 v168, v168, v164
    v_add_f32 v169, v169, v165
    v_add_f32 v170, v170, v166
    v_add_f32 v171, v171, v167
    v_cvt_pk_bf16_f32 v168, v168, v169
    v_cvt_pk_bf16_f32 v169, v170, v171
    s_add_u32 s75, s71, 110592
    s_add_u32 s75, s75, s85
    buffer_store_dwordx2 v[168:169], v9, s[52:55], s75 offen offset:1024
    s_waitcnt lgkmcnt(14)
    v_add_f32 v184, v184, v172
    v_add_f32 v185, v185, v173
    v_add_f32 v186, v186, v174
    v_add_f32 v187, v187, v175
    s_waitcnt lgkmcnt(13)
    v_add_f32 v184, v184, v176
    v_add_f32 v185, v185, v177
    v_add_f32 v186, v186, v178
    v_add_f32 v187, v187, v179
    s_waitcnt lgkmcnt(12)
    v_add_f32 v184, v184, v180
    v_add_f32 v185, v185, v181
    v_add_f32 v186, v186, v182
    v_add_f32 v187, v187, v183
    v_cvt_pk_bf16_f32 v184, v184, v185
    v_cvt_pk_bf16_f32 v185, v186, v187
    s_add_u32 s75, s71, 147456
    s_add_u32 s75, s75, s82
    buffer_store_dwordx2 v[184:185], v9, s[52:55], s75 offen offset:96
    s_waitcnt lgkmcnt(11)
    v_add_f32 v200, v200, v188
    v_add_f32 v201, v201, v189
    v_add_f32 v202, v202, v190
    v_add_f32 v203, v203, v191
    s_waitcnt lgkmcnt(10)
    v_add_f32 v200, v200, v192
    v_add_f32 v201, v201, v193
    v_add_f32 v202, v202, v194
    v_add_f32 v203, v203, v195
    s_waitcnt lgkmcnt(9)
    v_add_f32 v200, v200, v196
    v_add_f32 v201, v201, v197
    v_add_f32 v202, v202, v198
    v_add_f32 v203, v203, v199
    v_cvt_pk_bf16_f32 v200, v200, v201
    v_cvt_pk_bf16_f32 v201, v202, v203
    s_add_u32 s75, s72, 0
    s_add_u32 s75, s75, s82
    buffer_store_dwordx2 v[200:201], v9, s[52:55], s75 offen offset:64
    s_waitcnt lgkmcnt(8)
    v_add_f32 v216, v216, v204
    v_add_f32 v217, v217, v205
    v_add_f32 v218, v218, v206
    v_add_f32 v219, v219, v207
    s_waitcnt lgkmcnt(7)
    v_add_f32 v216, v216, v208
    v_add_f32 v217, v217, v209
    v_add_f32 v218, v218, v210
    v_add_f32 v219, v219, v211
    s_waitcnt lgkmcnt(6)
    v_add_f32 v216, v216, v212
    v_add_f32 v217, v217, v213
    v_add_f32 v218, v218, v214
    v_add_f32 v219, v219, v215
    v_cvt_pk_bf16_f32 v216, v216, v217
    v_cvt_pk_bf16_f32 v217, v218, v219
    s_add_u32 s75, s72, 36864
    s_add_u32 s75, s75, s82
    buffer_store_dwordx2 v[216:217], v9, s[52:55], s75 offen offset:64
    s_waitcnt lgkmcnt(5)
    v_add_f32 v232, v232, v220
    v_add_f32 v233, v233, v221
    v_add_f32 v234, v234, v222
    v_add_f32 v235, v235, v223
    s_waitcnt lgkmcnt(4)
    v_add_f32 v232, v232, v224
    v_add_f32 v233, v233, v225
    v_add_f32 v234, v234, v226
    v_add_f32 v235, v235, v227
    s_waitcnt lgkmcnt(3)
    v_add_f32 v232, v232, v228
    v_add_f32 v233, v233, v229
    v_add_f32 v234, v234, v230
    v_add_f32 v235, v235, v231
    v_cvt_pk_bf16_f32 v232, v232, v233
    v_cvt_pk_bf16_f32 v233, v234, v235
    s_add_u32 s75, s72, 73728
    s_add_u32 s75, s75, s82
    buffer_store_dwordx2 v[232:233], v9, s[52:55], s75 offen offset:64
    s_waitcnt lgkmcnt(2)
    v_add_f32 v248, v248, v236
    v_add_f32 v249, v249, v237
    v_add_f32 v250, v250, v238
    v_add_f32 v251, v251, v239
    s_waitcnt lgkmcnt(1)
    v_add_f32 v248, v248, v240
    v_add_f32 v249, v249, v241
    v_add_f32 v250, v250, v242
    v_add_f32 v251, v251, v243
    s_waitcnt lgkmcnt(0)
    v_add_f32 v248, v248, v244
    v_add_f32 v249, v249, v245
    v_add_f32 v250, v250, v246
    v_add_f32 v251, v251, v247
    v_cvt_pk_bf16_f32 v248, v248, v249
    v_cvt_pk_bf16_f32 v249, v250, v251
    s_add_u32 s75, s72, 110592
    s_add_u32 s75, s75, s82
    buffer_store_dwordx2 v[248:249], v9, s[52:55], s75 offen offset:64
    s_nop 1
    s_branch L_bail
L_spin_2:
L_fw_15:
    s_sub_u32 s90, s90, 1
    s_cbranch_scc1 L_bail
    ds_read_b32 v7, v4 offset:256
    s_waitcnt lgkmcnt(0)
    v_cmp_gt_u32 vcc, s70, v7
    s_cbranch_vccnz L_fw_15
    s_branch L_spinb_3
L_spin_4:
L_fw_16:
    s_sub_u32 s90, s90, 1
    s_cbranch_scc1 L_bail
    ds_read_b32 v7, v4 offset:256
    s_waitcnt lgkmcnt(0)
    v_cmp_gt_u32 vcc, s70, v7
    s_cbranch_vccnz L_fw_16
    s_branch L_spinb_5
L_A:
    s_setprio 2
    s_getpc_b64 s[4:5]
L_pc0:
    s_sub_u32 s4, s4, L_pc0-concat_heads__mha_block_cached__gqa_block_cached__near_ridge_kernel
    s_subb_u32 s5, s5, 0
    v_lshlrev_b32 v11, 7, v0
    s_lshl_b32 s85, s65, 13
    v_add_u32 v11, s85, v11
    v_min_u32 v11, L_end-concat_heads__mha_block_cached__gqa_block_cached__near_ridge_kernel, v11
    global_load_dword v40, v11, s[4:5]
    v_lshrrev_b32 v9, 4, v0
    v_lshlrev_b32 v11, 1, v9
    v_and_b32 v10, 7, v0
    v_xor_b32 v10, v10, v11
    v_lshrrev_b32 v11, 3, v0
    v_lshlrev_b32 v1, 8, v11
    v_lshl_add_u32 v1, v10, 4, v1
    v_and_b32 v10, 15, v0
    v_and_b32 v11, 6, v0
    v_xor_b32 v11, v11, v9
    v_lshlrev_b32 v2, 7, v10
    v_lshl_add_u32 v2, v11, 4, v2
    v_xor_b32 v3, 64, v2
    v_lshrrev_b32 v10, 2, v0
    v_lshlrev_b32 v4, 7, v10
    v_bfe_u32 v11, v0, 3, 2
    v_lshl_add_u32 v4, v11, 5, v4
    v_and_b32 v11, 3, v0
    v_lshl_add_u32 v4, v11, 3, v4
    v_xor_b32 v5, 32, v4
    v_xor_b32 v6, 64, v4
    v_xor_b32 v7, 96, v4
    v_lshlrev_b32 v8, 2, v0
    v_add_u32 v8, 161792, v8
    v_mov_b32 v12, 0x3f803f80
    v_mov_b32 v13, 0x3f803f80
    v_mov_b32 v14, 0x3f803f80
    v_mov_b32 v15, 0x3f803f80
    s_lshl_b32 s76, s65, 10
    s_add_u32 s77, s76, 3968
    s_add_u32 s78, s76, 8192
    s_add_u32 s79, s77, 8192
    s_lshl_b32 s73, s67, 3
    s_add_u32 s73, s73, s68
    s_lshl_b32 s73, s73, 19
    s_lshl_b32 s85, s65, 11
    s_add_u32 s73, s73, s85
    s_mov_b32 s87, 4294918144
    s_lshl_b32 s85, s66, 3
    s_add_u32 s85, s85, s68
    s_mul_i32 s83, s85, 147456
    s_mov_b32 s72, 0
    s_mov_b32 s81, 0
    s_mov_b32 s84, 63
    s_mov_b32 s101, 0
    v_mov_b32 v160, 0
    v_mov_b32 v161, 0
    v_mov_b32 v162, 0
    v_mov_b32 v163, 0
    v_mov_b32 v164, 0
    v_mov_b32 v165, 0
    v_mov_b32 v166, 0
    v_mov_b32 v167, 0
    v_mov_b32 v168, 0
    v_mov_b32 v169, 0
    v_mov_b32 v170, 0
    v_mov_b32 v171, 0
    v_mov_b32 v172, 0
    v_mov_b32 v173, 0
    v_mov_b32 v174, 0
    v_mov_b32 v175, 0
    v_mov_b32 v176, 0
    v_mov_b32 v177, 0
    v_mov_b32 v178, 0
    v_mov_b32 v179, 0
    v_mov_b32 v180, 0
    v_mov_b32 v181, 0
    v_mov_b32 v182, 0
    v_mov_b32 v183, 0
    v_mov_b32 v184, 0
    v_mov_b32 v185, 0
    v_mov_b32 v186, 0
    v_mov_b32 v187, 0
    v_mov_b32 v188, 0
    v_mov_b32 v189, 0
    v_mov_b32 v190, 0
    v_mov_b32 v191, 0
    v_mov_b32 v192, 0
    v_mov_b32 v193, 0
    v_mov_b32 v194, 0
    v_mov_b32 v195, 0
    v_mov_b32 v196, 0
    v_mov_b32 v197, 0
    v_mov_b32 v198, 0
    v_mov_b32 v199, 0
    v_mov_b32 v200, 0
    v_mov_b32 v201, 0
    v_mov_b32 v202, 0
    v_mov_b32 v203, 0
    v_mov_b32 v204, 0
    v_mov_b32 v205, 0
    v_mov_b32 v206, 0
    v_mov_b32 v207, 0
    v_mov_b32 v208, 0
    v_mov_b32 v209, 0
    v_mov_b32 v210, 0
    v_mov_b32 v211, 0
    v_mov_b32 v212, 0
    v_mov_b32 v213, 0
    v_mov_b32 v214, 0
    v_mov_b32 v215, 0
    v_mov_b32 v216, 0
    v_mov_b32 v217, 0
    v_mov_b32 v218, 0
    v_mov_b32 v219, 0
    v_mov_b32 v220, 0
    v_mov_b32 v221, 0
    v_mov_b32 v222, 0
    v_mov_b32 v223, 0
    v_mov_b32 v224, 0
    v_mov_b32 v225, 0
    v_mov_b32 v226, 0
    v_mov_b32 v227, 0
    v_mov_b32 v228, 0
    v_mov_b32 v229, 0
    v_mov_b32 v230, 0
    v_mov_b32 v231, 0
    v_mov_b32 v232, 0
    v_mov_b32 v233, 0
    v_mov_b32 v234, 0
    v_mov_b32 v235, 0
    v_mov_b32 v236, 0
    v_mov_b32 v237, 0
    v_mov_b32 v238, 0
    v_mov_b32 v239, 0
    v_mov_b32 v240, 0
    v_mov_b32 v241, 0
    v_mov_b32 v242, 0
    v_mov_b32 v243, 0
    v_mov_b32 v244, 0
    v_mov_b32 v245, 0
    v_mov_b32 v246, 0
    v_mov_b32 v247, 0
    v_mov_b32 v248, 0
    v_mov_b32 v249, 0
    v_mov_b32 v250, 0
    v_mov_b32 v251, 0
    v_mov_b32 v252, 0
    v_mov_b32 v253, 0
    v_mov_b32 v254, 0
    v_mov_b32 v255, 0
    v_mov_b32 v16, 0
    v_mov_b32 v17, 0
    v_mov_b32 v18, 0
    v_mov_b32 v19, 0
    v_mov_b32 v20, 0
    v_mov_b32 v21, 0
    v_mov_b32 v22, 0
    v_mov_b32 v23, 0
    v_mov_b32 v24, 0
    v_mov_b32 v25, 0
    v_mov_b32 v26, 0
    v_mov_b32 v27, 0
    v_mov_b32 v28, 0
    v_mov_b32 v29, 0
    v_mov_b32 v30, 0
    v_mov_b32 v31, 0
    v_mov_b32 v32, 0
    v_mov_b32 v33, 0
    v_mov_b32 v34, 0
    v_mov_b32 v35, 0
    v_mov_b32 v36, 0
    v_mov_b32 v37, 0
    v_mov_b32 v38, 0
    v_mov_b32 v39, 0
    s_mov_b32 s74, 0xff800000
    s_mov_b32 s75, 0xff800000
    s_mov_b32 s71, 65554
    s_cmp_lg_u32 s65, 0
    s_cbranch_scc1 L_noinit_17
    s_lshl_b32 s82, s67, 3
    s_add_u32 s82, s82, s68
    s_mul_i32 s85, s82, 36864
    v_lshrrev_b32 v10, 3, v0
    v_and_b32 v9, 7, v0
    v_mul_u32_u24 v11, 1152, v10
    v_lshl_add_u32 v11, v9, 4, v11
    buffer_load_dwordx4 v[64:67], v11, s[48:51], s85 offen offset:1024
    s_add_u32 s85, s85, 9216
    buffer_load_dwordx4 v[68:71], v11, s[48:51], s85 offen offset:1024
    s_add_u32 s85, s85, 9216
    buffer_load_dwordx4 v[72:75], v11, s[48:51], s85 offen offset:1024
    s_add_u32 s85, s85, 9216
    buffer_load_dwordx4 v[76:79], v11, s[48:51], s85 offen offset:1024
    s_add_u32 s85, s85, 9216
    v_lshrrev_b32 v11, 1, v9
    v_lshlrev_b32 v11, 17, v11
    v_lshl_add_u32 v11, v10, 5, v11
    v_and_b32 v9, 1, v9
    v_lshl_add_u32 v11, v9, 4, v11
    s_lshl_b32 s85, s82, 10
    s_lshl_b32 s82, s69, 19
    s_add_u32 s85, s85, s82
    s_add_u32 s85, s85, 41999872
    s_waitcnt vmcnt(0)
    buffer_store_dwordx4 v[64:67], v11, s[60:63], s85 offen offset:0 sc1
    buffer_store_dwordx4 v[68:71], v11, s[60:63], s85 offen offset:256 sc1
    buffer_store_dwordx4 v[72:75], v11, s[60:63], s85 offen offset:512 sc1
    buffer_store_dwordx4 v[76:79], v11, s[60:63], s85 offen offset:768 sc1
    s_lshl_b32 s85, s66, 3
    s_add_u32 s85, s85, s68
    s_lshl_b32 s85, s85, 8
    s_add_u32 s85, s85, 40000000
    v_mov_b32 v10, s85
    v_mov_b32 v9, 0
    s_mov_b64 exec, 1
    buffer_store_dword v9, v10, s[60:63], 0 offen sc1
    s_mov_b64 exec, -1
    s_waitcnt vmcnt(0)
    s_lshl_b32 s85, s69, 7
    v_mov_b32 v10, s85
    v_mov_b32 v9, 1
    s_mov_b64 exec, 1
    buffer_atomic_add v9, v10, s[56:59], 0 offen sc1
    s_mov_b64 exec, -1
L_noinit_17:
    s_mov_b32 s85, 64
L_fw_18:
    s_sleep 2
    s_sub_u32 s90, s90, 1
    s_cbranch_scc1 L_bail
    ds_read_b32 v9, v8 offset:256
    s_waitcnt lgkmcnt(0)
    v_cmp_gt_u32 vcc, s85, v9
    s_cbranch_vccnz L_fw_18
    s_add_u32 m0, s72, s76
    s_nop 0
    buffer_load_dwordx4 v1, s[36:39], s73 offen nt lds
    s_add_u32 m0, s72, s77
    s_nop 0
    buffer_load_dwordx4 v1, s[36:39], s73 offen offset:128 nt lds
    s_waitcnt vmcnt(2)
    s_add_u32 m0, s72, s78
    s_nop 0
    buffer_load_dwordx4 v1, s[40:43], s73 offen nt lds
    s_add_u32 m0, s72, s79
    s_nop 0
    buffer_load_dwordx4 v1, s[40:43], s73 offen offset:128 nt lds
    s_add_u32 s73, s73, 8192
    s_sub_u32 s84, s84, 1
    s_cselect_b32 s73, 1073741824, s73
    s_add_u32 s72, s72, 16384
    s_and_b32 s72, s72, 65535
    s_cmp_eq_u32 s72, 49152
    s_cselect_b32 s86, s87, 16384
    s_waitcnt vmcnt(2)
    s_add_u32 m0, s72, s76
    s_nop 0
    buffer_load_dwordx4 v1, s[36:39], s73 offen nt lds
    s_add_u32 m0, s72, s77
    s_nop 0
    buffer_load_dwordx4 v1, s[36:39], s73 offen offset:128 nt lds
    s_waitcnt vmcnt(2)
    s_add_u32 m0, s72, s78
    s_nop 0
    buffer_load_dwordx4 v1, s[40:43], s73 offen nt lds
    s_add_u32 m0, s72, s79
    s_nop 0
    buffer_load_dwordx4 v1, s[40:43], s73 offen offset:128 nt lds
    s_add_u32 s73, s73, 8192
    s_sub_u32 s84, s84, 1
    s_cselect_b32 s73, 1073741824, s73
    s_add_u32 s72, s72, 16384
    s_and_b32 s72, s72, 65535
    s_cmp_eq_u32 s72, 49152
    s_cselect_b32 s86, s87, 16384
    s_waitcnt vmcnt(2)
    s_add_u32 m0, s72, s76
    s_nop 0
    buffer_load_dwordx4 v1, s[36:39], s73 offen nt lds
    s_add_u32 m0, s72, s77
    s_nop 0
    buffer_load_dwordx4 v1, s[36:39], s73 offen offset:128 nt lds
    s_waitcnt vmcnt(2)
    s_add_u32 m0, s72, s78
    s_nop 0
    buffer_load_dwordx4 v1, s[40:43], s73 offen nt lds
    s_add_u32 m0, s72, s79
    s_nop 0
    buffer_load_dwordx4 v1, s[40:43], s73 offen offset:128 nt lds
    s_add_u32 s73, s73, 8192
    s_sub_u32 s84, s84, 1
    s_cselect_b32 s73, 1073741824, s73
    s_add_u32 s72, s72, 16384
    s_and_b32 s72, s72, 65535
    s_cmp_eq_u32 s72, 49152
    s_cselect_b32 s86, s87, 16384
    s_waitcnt vmcnt(2)
    s_add_u32 m0, s72, s76
    s_nop 0
    buffer_load_dwordx4 v1, s[36:39], s73 offen nt lds
    s_add_u32 m0, s72, s77
    s_nop 0
    buffer_load_dwordx4 v1, s[36:39], s73 offen offset:128 nt lds
    s_waitcnt vmcnt(2)
    s_mov_b32 s85, 4
L_fw_19:
    s_sleep 1
    s_sub_u32 s90, s90, 1
    s_cbranch_scc1 L_bail
    ds_read_b32 v9, v8 offset:512
    s_waitcnt lgkmcnt(0)
    v_cmp_gt_u32 vcc, s85, v9
    s_cbranch_vccnz L_fw_19
    s_mov_b32 s85, 73728
    v_lshlrev_b32 v11, 4, v0
    v_add_u32 v11, s85, v11
    ds_read_b128 v[144:147], v11 offset:32768
    ds_read_b128 v[148:151], v11 offset:33792
    ds_read_b128 v[152:155], v11 offset:34816
    ds_read_b128 v[156:159], v11 offset:35840
    s_lshl_b32 s82, s65, 13
    v_add_u32 v11, s82, v11
    ds_read_b128 v[112:115], v11 offset:0
    ds_read_b128 v[116:119], v11 offset:1024
    ds_read_b128 v[120:123], v11 offset:2048
    ds_read_b128 v[124:127], v11 offset:3072
    ds_read_b128 v[128:131], v11 offset:4096
    ds_read_b128 v[132:135], v11 offset:5120
    ds_read_b128 v[136:139], v11 offset:6144
    ds_read_b128 v[140:143], v11 offset:7168
    s_cmp_eq_u32 s65, 0
    s_cbranch_scc1 L_q1skip_20
    s_mov_b32 s85, 110592
    v_lshlrev_b32 v11, 4, v0
    v_add_u32 v11, s85, v11
    ds_read_b128 v[144:147], v11 offset:32768
    ds_read_b128 v[148:151], v11 offset:33792
    ds_read_b128 v[152:155], v11 offset:34816
    ds_read_b128 v[156:159], v11 offset:35840
    s_lshl_b32 s82, s65, 13
    v_add_u32 v11, s82, v11
    ds_read_b128 v[224:227], v11 offset:0
    ds_read_b128 v[228:231], v11 offset:1024
    ds_read_b128 v[232:235], v11 offset:2048
    ds_read_b128 v[236:239], v11 offset:3072
    ds_read_b128 v[240:243], v11 offset:4096
    ds_read_b128 v[244:247], v11 offset:5120
    ds_read_b128 v[248:251], v11 offset:6144
    ds_read_b128 v[252:255], v11 offset:7168
L_q1skip_20:
    s_waitcnt lgkmcnt(0)
    ds_inc_u32 v8, v12 offset:768
    s_waitcnt vmcnt(10)
    s_mov_b32 s70, 4
    ds_inc_u32 v8, v12 offset:0
L_fw_21:
    s_sub_u32 s90, s90, 1
    s_cbranch_scc1 L_bail
    ds_read_b32 v9, v8 offset:0
    s_waitcnt lgkmcnt(0)
    v_cmp_gt_u32 vcc, s70, v9
    s_cbranch_vccnz L_fw_21
    ds_read_b128 v[64:67], v2 offset:0
    ds_read_b128 v[68:71], v3 offset:0
    ds_read_b128 v[72:75], v2 offset:4096
    ds_read_b128 v[76:79], v3 offset:4096
    ds_read_b128 v[80:83], v2 offset:2048
    ds_read_b128 v[84:87], v3 offset:2048
    ds_read_b128 v[88:91], v2 offset:6144
    ds_read_b128 v[92:95], v3 offset:6144
    s_waitcnt lgkmcnt(0)
    s_cmp_eq_u32 s65, 0
    s_nop 1
    s_cbranch_scc1 L_A3_0
.p2align 6
L_A2_0:
    s_waitcnt lgkmcnt(4)
    v_mfma_f32_16x16x32_bf16 v[40:43], v[64:67], v[112:115], v[28:31]
    ds_read_b64_tr_b16 v[96:97], v4 offset:8192
    ds_read_b64_tr_b16 v[98:99], v4 offset:10240
    v_mfma_f32_16x16x32_bf16 v[40:43], v[68:71], v[116:119], v[40:43]
    ds_read_b64_tr_b16 v[100:101], v5 offset:8192
    s_add_u32 m0, s72, s78
    v_mfma_f32_16x16x32_bf16 v[40:43], v[72:75], v[120:123], v[40:43]
    ds_read_b64_tr_b16 v[102:103], v5 offset:10240
    v_mfma_f32_16x16x32_bf16 v[40:43], v[76:79], v[124:127], v[40:43]
    ds_read_b64_tr_b16 v[104:105], v6 offset:8192
    ds_read_b64_tr_b16 v[106:107], v6 offset:10240
    s_waitcnt lgkmcnt(8)
    v_mfma_f32_16x16x32_bf16 v[44:47], v[80:83], v[112:115], v[28:31]
    buffer_load_dwordx4 v1, s[40:43], s73 offen nt lds
    s_add_u32 m0, s72, s79
    v_mfma_f32_16x16x32_bf16 v[44:47], v[84:87], v[116:119], v[44:47]
    ds_read_b64_tr_b16 v[108:109], v7 offset:8192
    ds_read_b64_tr_b16 v[110:111], v7 offset:10240
    s_waitcnt lgkmcnt(8)
    v_mfma_f32_16x16x32_bf16 v[44:47], v[88:91], v[120:123], v[44:47]
    buffer_load_dwordx4 v1, s[40:43], s73 offen offset:128 nt lds
    v_mfma_f32_16x16x32_bf16 v[44:47], v[92:95], v[124:127], v[44:47]
    s_add_u32 s73, s73, 8192
    s_sub_u32 s84, s84, 1
    s_cselect_b32 s73, 1073741824, s73
    s_add_u32 s72, s72, 16384
    v_mfma_f32_16x16x32_bf16 v[48:51], v[64:67], v[128:131], v[32:35]
    ds_read_b64_tr_b16 v[64:65], v4 offset:12288
    s_and_b32 s72, s72, 65535
    v_mfma_f32_16x16x32_bf16 v[48:51], v[68:71], v[132:135], v[48:51]
    ds_read_b64_tr_b16 v[66:67], v4 offset:14336
    s_cmp_eq_u32 s72, 49152
    s_cselect_b32 s86, s87, 16384
    v_mfma_f32_16x16x32_bf16 v[48:51], v[72:75], v[136:139], v[48:51]
    ds_read_b64_tr_b16 v[68:69], v5 offset:12288
    s_waitcnt vmcnt(10)
    ds_inc_u32 v8, v12 offset:0
    v_mfma_f32_16x16x32_bf16 v[48:51], v[76:79], v[140:143], v[48:51]
    ds_read_b64_tr_b16 v[70:71], v5 offset:14336
    s_add_u32 s70, s70, 4
    v_mfma_f32_16x16x32_bf16 v[52:55], v[80:83], v[128:131], v[32:35]
    ds_read_b64_tr_b16 v[72:73], v6 offset:12288
    v_add_u32 v2, s86, v2
    v_mfma_f32_16x16x32_bf16 v[52:55], v[84:87], v[132:135], v[52:55]
    ds_read_b64_tr_b16 v[74:75], v6 offset:14336
    v_add_u32 v3, s86, v3
    v_mfma_f32_16x16x32_bf16 v[52:55], v[88:91], v[136:139], v[52:55]
    ds_read_b64_tr_b16 v[76:77], v7 offset:12288
    ds_read_b64_tr_b16 v[78:79], v7 offset:14336
    ds_read_b32 v9, v8 offset:0
    v_max3_f32 v10, v40, v41, v42
    v_max3_f32 v10, v10, v43, v44
    v_max3_f32 v10, v10, v45, v46
    v_max_f32 v10, v10, v47
    v_cmp_lt_f32 s[92:93], s74, v10
    s_nop 0
    s_cmp_lg_u64 s[92:93], 0
    s_cbranch_scc1 L_rare_22
L_rareb_23:
    v_exp_f32 v40, v40
    v_exp_f32 v41, v41
    v_exp_f32 v42, v42
    v_cvt_pk_bf16_f32 v40, v40, v41
    v_exp_f32 v43, v43
    v_exp_f32 v44, v44
    v_cvt_pk_bf16_f32 v41, v42, v43
    v_exp_f32 v45, v45
    v_exp_f32 v46, v46
    v_cvt_pk_bf16_f32 v42, v44, v45
    v_exp_f32 v47, v47
    s_nop 0
    v_cvt_pk_bf16_f32 v43, v46, v47
    v_mfma_f32_16x16x32_bf16 v[52:55], v[92:95], v[140:143], v[52:55]
    s_waitcnt lgkmcnt(10)
    v_mfma_f32_16x16x32_bf16 v[160:163], v[96:99], v[40:43], v[160:163]
    s_waitcnt lgkmcnt(0)
    v_cmp_gt_u32 s[98:99], s70, v9
    v_add_u32 v4, s86, v4
    v_add_u32 v5, s86, v5
    v_mfma_f32_16x16x32_bf16 v[164:167], v[100:103], v[40:43], v[164:167]
    v_max3_f32 v10, v48, v49, v50
    v_max3_f32 v10, v10, v51, v52
    v_max3_f32 v10, v10, v53, v54
    v_max_f32 v10, v10, v55
    v_cmp_lt_f32 s[94:95], s74, v10
    v_mfma_f32_16x16x32_bf16 v[168:171], v[104:107], v[40:43], v[168:171]
    v_add_u32 v6, s86, v6
    v_add_u32 v7, s86, v7
    v_mfma_f32_16x16x32_bf16 v[172:175], v[108:111], v[40:43], v[172:175]
    s_or_b64 s[98:99], s[98:99], s[94:95]
    s_cbranch_scc1 L_rare_24
L_rareb_25:
    v_mfma_f32_16x16x32_bf16 v[176:179], v[64:67], v[40:43], v[176:179]
    v_exp_f32 v48, v48
    v_mfma_f32_16x16x32_bf16 v[180:183], v[68:71], v[40:43], v[180:183]
    ds_read_b128 v[80:83], v2 offset:0
    v_exp_f32 v49, v49
    v_mfma_f32_16x16x32_bf16 v[184:187], v[72:75], v[40:43], v[184:187]
    ds_read_b128 v[84:87], v3 offset:0
    v_exp_f32 v50, v50
    v_mfma_f32_16x16x32_bf16 v[188:191], v[76:79], v[40:43], v[188:191]
    ds_read_b128 v[88:91], v2 offset:4096
    v_cvt_pk_bf16_f32 v48, v48, v49
    v_exp_f32 v51, v51
    v_exp_f32 v52, v52
    v_cvt_pk_bf16_f32 v49, v50, v51
    v_exp_f32 v53, v53
    v_exp_f32 v54, v54
    v_cvt_pk_bf16_f32 v50, v52, v53
    v_exp_f32 v55, v55
    s_nop 0
    v_cvt_pk_bf16_f32 v51, v54, v55
    v_mfma_f32_16x16x32_bf16 v[16:19], v[12:15], v[40:43], v[16:19]
    ds_read_b128 v[92:95], v3 offset:4096
    s_waitcnt vmcnt(8)
    v_mfma_f32_16x16x32_bf16 v[192:195], v[96:99], v[48:51], v[192:195]
    ds_read_b128 v[96:99], v2 offset:2048
    v_mfma_f32_16x16x32_bf16 v[196:199], v[100:103], v[48:51], v[196:199]
    ds_read_b128 v[100:103], v3 offset:2048
    ds_inc_u32 v8, v12 offset:0
    v_mfma_f32_16x16x32_bf16 v[200:203], v[104:107], v[48:51], v[200:203]
    ds_read_b128 v[104:107], v2 offset:6144
    s_add_u32 s70, s70, 4
    v_mfma_f32_16x16x32_bf16 v[204:207], v[108:111], v[48:51], v[204:207]
    ds_read_b128 v[108:111], v3 offset:6144
    v_mfma_f32_16x16x32_bf16 v[208:211], v[64:67], v[48:51], v[208:211]
    ds_read_b32 v9, v8 offset:0
    s_add_u32 m0, s72, s76
    v_mfma_f32_16x16x32_bf16 v[212:215], v[68:71], v[48:51], v[212:215]
    buffer_load_dwordx4 v1, s[36:39], s73 offen nt lds
    s_add_u32 m0, s72, s77
    v_mfma_f32_16x16x32_bf16 v[216:219], v[72:75], v[48:51], v[216:219]
    buffer_load_dwordx4 v1, s[36:39], s73 offen offset:128 nt lds
    v_mfma_f32_16x16x32_bf16 v[220:223], v[76:79], v[48:51], v[220:223]
    s_lshr_b32 s71, s71, 1
    s_and_b32 s100, s71, 1
    s_waitcnt lgkmcnt(0)
    v_cmp_gt_u32 s[98:99], s70, v9
    v_mfma_f32_16x16x32_bf16 v[20:23], v[12:15], v[48:51], v[20:23]
    s_or_b64 s[98:99], s[98:99], s[100:101]
    s_cbranch_scc1 L_cpe_26
L_cpeb_27:
L_A2_1:
    s_waitcnt lgkmcnt(4)
    v_mfma_f32_16x16x32_bf16 v[40:43], v[80:83], v[112:115], v[28:31]
    ds_read_b64_tr_b16 v[64:65], v4 offset:8192
    ds_read_b64_tr_b16 v[66:67], v4 offset:10240
    v_mfma_f32_16x16x32_bf16 v[40:43], v[84:87], v[116:119], v[40:43]
    ds_read_b64_tr_b16 v[68:69], v5 offset:8192
    s_add_u32 m0, s72, s78
    v_mfma_f32_16x16x32_bf16 v[40:43], v[88:91], v[120:123], v[40:43]
    ds_read_b64_tr_b16 v[70:71], v5 offset:10240
    v_mfma_f32_16x16x32_bf16 v[40:43], v[92:95], v[124:127], v[40:43]
    ds_read_b64_tr_b16 v[72:73], v6 offset:8192
    ds_read_b64_tr_b16 v[74:75], v6 offset:10240
    s_waitcnt lgkmcnt(8)
    v_mfma_f32_16x16x32_bf16 v[44:47], v[96:99], v[112:115], v[28:31]
    buffer_load_dwordx4 v1, s[40:43], s73 offen nt lds
    s_add_u32 m0, s72, s79
    v_mfma_f32_16x16x32_bf16 v[44:47], v[100:103], v[116:119], v[44:47]
    ds_read_b64_tr_b16 v[76:77], v7 offset:8192
    ds_read_b64_tr_b16 v[78:79], v7 offset:10240
    s_waitcnt lgkmcnt(8)
    v_mfma_f32_16x16x32_bf16 v[44:47], v[104:107], v[120:123], v[44:47]
    buffer_load_dwordx4 v1, s[40:43], s73 offen offset:128 nt lds
    v_mfma_f32_16x16x32_bf16 v[44:47], v[108:111], v[124:127], v[44:47]
    s_add_u32 s73, s73, 8192
    s_sub_u32 s84, s84, 1
    s_cselect_b32 s73, 1073741824, s73
    s_add_u32 s72, s72, 16384
    v_mfma_f32_16x16x32_bf16 v[48:51], v[80:83], v[128:131], v[32:35]
    ds_read_b64_tr_b16 v[80:81], v4 offset:12288
    s_and_b32 s72, s72, 65535
    v_mfma_f32_16x16x32_bf16 v[48:51], v[84:87], v[132:135], v[48:51]
    ds_read_b64_tr_b16 v[82:83], v4 offset:14336
    s_cmp_eq_u32 s72, 49152
    s_cselect_b32 s86, s87, 16384
    v_mfma_f32_16x16x32_bf16 v[48:51], v[88:91], v[136:139], v[48:51]
    ds_read_b64_tr_b16 v[84:85], v5 offset:12288
    s_waitcnt vmcnt(10)
    ds_inc_u32 v8, v12 offset:0
    v_mfma_f32_16x16x32_bf16 v[48:51], v[92:95], v[140:143], v[48:51]
    ds_read_b64_tr_b16 v[86:87], v5 offset:14336
    s_add_u32 s70, s70, 4
    v_mfma_f32_16x16x32_bf16 v[52:55], v[96:99], v[128:131], v[32:35]
    ds_read_b64_tr_b16 v[88:89], v6 offset:12288
    v_add_u32 v2, s86, v2
    v_mfma_f32_16x16x32_bf16 v[52:55], v[100:103], v[132:135], v[52:55]
    ds_read_b64_tr_b16 v[90:91], v6 offset:14336
    v_add_u32 v3, s86, v3
    v_mfma_f32_16x16x32_bf16 v[52:55], v[104:107], v[136:139], v[52:55]
    ds_read_b64_tr_b16 v[92:93], v7 offset:12288
    ds_read_b64_tr_b16 v[94:95], v7 offset:14336
    ds_read_b32 v9, v8 offset:0
    v_max3_f32 v10, v40, v41, v42
    v_max3_f32 v10, v10, v43, v44
    v_max3_f32 v10, v10, v45, v46
    v_max_f32 v10, v10, v47
    v_cmp_lt_f32 s[92:93], s74, v10
    s_nop 0
    s_cmp_lg_u64 s[92:93], 0
    s_cbranch_scc1 L_rare_28
L_rareb_29:
    v_exp_f32 v40, v40
    v_exp_f32 v41, v41
    v_exp_f32 v42, v42
    v_cvt_pk_bf16_f32 v40, v40, v41
    v_exp_f32 v43, v43
    v_exp_f32 v44, v44
    v_cvt_pk_bf16_f32 v41, v42, v43
    v_exp_f32 v45, v45
    v_exp_f32 v46, v46
    v_cvt_pk_bf16_f32 v42, v44, v45
    v_exp_f32 v47, v47
    s_nop 0
    v_cvt_pk_bf16_f32 v43, v46, v47
    v_mfma_f32_16x16x32_bf16 v[52:55], v[108:111], v[140:143], v[52:55]
    s_waitcnt lgkmcnt(10)
    v_mfma_f32_16x16x32_bf16 v[160:163], v[64:67], v[40:43], v[160:163]
    s_waitcnt lgkmcnt(0)
    v_cmp_gt_u32 s[98:99], s70, v9
    v_add_u32 v4, s86, v4
    v_add_u32 v5, s86, v5
    v_mfma_f32_16x16x32_bf16 v[164:167], v[68:71], v[40:43], v[164:167]
    v_max3_f32 v10, v48, v49, v50
    v_max3_f32 v10, v10, v51, v52
    v_max3_f32 v10, v10, v53, v54
    v_max_f32 v10, v10, v55
    v_cmp_lt_f32 s[94:95], s74, v10
    v_mfma_f32_16x16x32_bf16 v[168:171], v[72:75], v[40:43], v[168:171]
    v_add_u32 v6, s86, v6
    v_add_u32 v7, s86, v7
    v_mfma_f32_16x16x32_bf16 v[172:175], v[76:79], v[40:43], v[172:175]
    s_or_b64 s[98:99], s[98:99], s[94:95]
    s_cbranch_scc1 L_rare_30
L_rareb_31:
    v_mfma_f32_16x16x32_bf16 v[176:179], v[80:83], v[40:43], v[176:179]
    v_exp_f32 v48, v48
    v_mfma_f32_16x16x32_bf16 v[180:183], v[84:87], v[40:43], v[180:183]
    ds_read_b128 v[96:99], v2 offset:0
    v_exp_f32 v49, v49
    v_mfma_f32_16x16x32_bf16 v[184:187], v[88:91], v[40:43], v[184:187]
    ds_read_b128 v[100:103], v3 offset:0
    v_exp_f32 v50, v50
    v_mfma_f32_16x16x32_bf16 v[188:191], v[92:95], v[40:43], v[188:191]
    ds_read_b128 v[104:107], v2 offset:4096
    v_cvt_pk_bf16_f32 v48, v48, v49
    v_exp_f32 v51, v51
    v_exp_f32 v52, v52
    v_cvt_pk_bf16_f32 v49, v50, v51
    v_exp_f32 v53, v53
    v_exp_f32 v54, v54
    v_cvt_pk_bf16_f32 v50, v52, v53
    v_exp_f32 v55, v55
    s_nop 0
    v_cvt_pk_bf16_f32 v51, v54, v55
    v_mfma_f32_16x16x32_bf16 v[16:19], v[12:15], v[40:43], v[16:19]
    ds_read_b128 v[108:111], v3 offset:4096
    s_waitcnt vmcnt(8)
    v_mfma_f32_16x16x32_bf16 v[192:195], v[64:67], v[48:51], v[192:195]
    ds_read_b128 v[64:67], v2 offset:2048
    v_mfma_f32_16x16x32_bf16 v[196:199], v[68:71], v[48:51], v[196:199]
    ds_read_b128 v[68:71], v3 offset:2048
    ds_inc_u32 v8, v12 offset:0
    v_mfma_f32_16x16x32_bf16 v[200:203], v[72:75], v[48:51], v[200:203]
    ds_read_b128 v[72:75], v2 offset:6144
    s_add_u32 s70, s70, 4
    v_mfma_f32_16x16x32_bf16 v[204:207], v[76:79], v[48:51], v[204:207]
    ds_read_b128 v[76:79], v3 offset:6144
    v_mfma_f32_16x16x32_bf16 v[208:211], v[80:83], v[48:51], v[208:211]
    ds_read_b32 v9, v8 offset:0
    s_add_u32 m0, s72, s76
    v_mfma_f32_16x16x32_bf16 v[212:215], v[84:87], v[48:51], v[212:215]
    buffer_load_dwordx4 v1, s[36:39], s73 offen nt lds
    s_add_u32 m0, s72, s77
    v_mfma_f32_16x16x32_bf16 v[216:219], v[88:91], v[48:51], v[216:219]
    buffer_load_dwordx4 v1, s[36:39], s73 offen offset:128 nt lds
    v_mfma_f32_16x16x32_bf16 v[220:223], v[92:95], v[48:51], v[220:223]
    s_lshr_b32 s71, s71, 1
    s_and_b32 s100, s71, 1
    s_waitcnt lgkmcnt(0)
    v_cmp_gt_u32 s[98:99], s70, v9
    v_mfma_f32_16x16x32_bf16 v[20:23], v[12:15], v[48:51], v[20:23]
    s_or_b64 s[98:99], s[98:99], s[100:101]
    s_cbranch_scc1 L_cpe_32
L_cpeb_33:
L_A2_2:
    s_waitcnt lgkmcnt(4)
    v_mfma_f32_16x16x32_bf16 v[40:43], v[96:99], v[112:115], v[28:31]
    ds_read_b64_tr_b16 v[80:81], v4 offset:8192
    ds_read_b64_tr_b16 v[82:83], v4 offset:10240
    v_mfma_f32_16x16x32_bf16 v[40:43], v[100:103], v[116:119], v[40:43]
    ds_read_b64_tr_b16 v[84:85], v5 offset:8192
    s_add_u32 m0, s72, s78
    v_mfma_f32_16x16x32_bf16 v[40:43], v[104:107], v[120:123], v[40:43]
    ds_read_b64_tr_b16 v[86:87], v5 offset:10240
    v_mfma_f32_16x16x32_bf16 v[40:43], v[108:111], v[124:127], v[40:43]
    ds_read_b64_tr_b16 v[88:89], v6 offset:8192
    ds_read_b64_tr_b16 v[90:91], v6 offset:10240
    s_waitcnt lgkmcnt(8)
    v_mfma_f32_16x16x32_bf16 v[44:47], v[64:67], v[112:115], v[28:31]
    buffer_load_dwordx4 v1, s[40:43], s73 offen nt lds
    s_add_u32 m0, s72, s79
    v_mfma_f32_16x16x32_bf16 v[44:47], v[68:71], v[116:119], v[44:47]
    ds_read_b64_tr_b16 v[92:93], v7 offset:8192
    ds_read_b64_tr_b16 v[94:95], v7 offset:10240
    s_waitcnt lgkmcnt(8)
    v_mfma_f32_16x16x32_bf16 v[44:47], v[72:75], v[120:123], v[44:47]
    buffer_load_dwordx4 v1, s[40:43], s73 offen offset:128 nt lds
    v_mfma_f32_16x16x32_bf16 v[44:47], v[76:79], v[124:127], v[44:47]
    s_add_u32 s73, s73, 8192
    s_sub_u32 s84, s84, 1
    s_cselect_b32 s73, 1073741824, s73
    s_add_u32 s72, s72, 16384
    v_mfma_f32_16x16x32_bf16 v[48:51], v[96:99], v[128:131], v[32:35]
    ds_read_b64_tr_b16 v[96:97], v4 offset:12288
    s_and_b32 s72, s72, 65535
    v_mfma_f32_16x16x32_bf16 v[48:51], v[100:103], v[132:135], v[48:51]
    ds_read_b64_tr_b16 v[98:99], v4 offset:14336
    s_cmp_eq_u32 s72, 49152
    s_cselect_b32 s86, s87, 16384
    v_mfma_f32_16x16x32_bf16 v[48:51], v[104:107], v[136:139], v[48:51]
    ds_read_b64_tr_b16 v[100:101], v5 offset:12288
    s_waitcnt vmcnt(10)
    ds_inc_u32 v8, v12 offset:0
    v_mfma_f32_16x16x32_bf16 v[48:51], v[108:111], v[140:143], v[48:51]
    ds_read_b64_tr_b16 v[102:103], v5 offset:14336
    s_add_u32 s70, s70, 4
    v_mfma_f32_16x16x32_bf16 v[52:55], v[64:67], v[128:131], v[32:35]
    ds_read_b64_tr_b16 v[104:105], v6 offset:12288
    v_add_u32 v2, s86, v2
    v_mfma_f32_16x16x32_bf16 v[52:55], v[68:71], v[132:135], v[52:55]
    ds_read_b64_tr_b16 v[106:107], v6 offset:14336
    v_add_u32 v3, s86, v3
    v_mfma_f32_16x16x32_bf16 v[52:55], v[72:75], v[136:139], v[52:55]
    ds_read_b64_tr_b16 v[108:109], v7 offset:12288
    ds_read_b64_tr_b16 v[110:111], v7 offset:14336
    ds_read_b32 v9, v8 offset:0
    v_max3_f32 v10, v40, v41, v42
    v_max3_f32 v10, v10, v43, v44
    v_max3_f32 v10, v10, v45, v46
    v_max_f32 v10, v10, v47
    v_cmp_lt_f32 s[92:93], s74, v10
    s_nop 0
    s_cmp_lg_u64 s[92:93], 0
    s_cbranch_scc1 L_rare_34
L_rareb_35:
    v_exp_f32 v40, v40
    v_exp_f32 v41, v41
    v_exp_f32 v42, v42
    v_cvt_pk_bf16_f32 v40, v40, v41
    v_exp_f32 v43, v43
    v_exp_f32 v44, v44
    v_cvt_pk_bf16_f32 v41, v42, v43
    v_exp_f32 v45, v45
    v_exp_f32 v46, v46
    v_cvt_pk_bf16_f32 v42, v44, v45
    v_exp_f32 v47, v47
    s_nop 0
    v_cvt_pk_bf16_f32 v43, v46, v47
    v_mfma_f32_16x16x32_bf16 v[52:55], v[76:79], v[140:143], v[52:55]
    s_waitcnt lgkmcnt(10)
    v_mfma_f32_16x16x32_bf16 v[160:163], v[80:83], v[40:43], v[160:163]
    s_waitcnt lgkmcnt(0)
    v_cmp_gt_u32 s[98:99], s70, v9
    v_add_u32 v4, s86, v4
    v_add_u32 v5, s86, v5
    v_mfma_f32_16x16x32_bf16 v[164:167], v[84:87], v[40:43], v[164:167]
    v_max3_f32 v10, v48, v49, v50
    v_max3_f32 v10, v10, v51, v52
    v_max3_f32 v10, v10, v53, v54
    v_max_f32 v10, v10, v55
    v_cmp_lt_f32 s[94:95], s74, v10
    v_mfma_f32_16x16x32_bf16 v[168:171], v[88:91], v[40:43], v[168:171]
    v_add_u32 v6, s86, v6
    v_add_u32 v7, s86, v7
    v_mfma_f32_16x16x32_bf16 v[172:175], v[92:95], v[40:43], v[172:175]
    s_or_b64 s[98:99], s[98:99], s[94:95]
    s_cbranch_scc1 L_rare_36
L_rareb_37:
    v_mfma_f32_16x16x32_bf16 v[176:179], v[96:99], v[40:43], v[176:179]
    v_exp_f32 v48, v48
    v_mfma_f32_16x16x32_bf16 v[180:183], v[100:103], v[40:43], v[180:183]
    ds_read_b128 v[64:67], v2 offset:0
    v_exp_f32 v49, v49
    v_mfma_f32_16x16x32_bf16 v[184:187], v[104:107], v[40:43], v[184:187]
    ds_read_b128 v[68:71], v3 offset:0
    v_exp_f32 v50, v50
    v_mfma_f32_16x16x32_bf16 v[188:191], v[108:111], v[40:43], v[188:191]
    ds_read_b128 v[72:75], v2 offset:4096
    v_cvt_pk_bf16_f32 v48, v48, v49
    v_exp_f32 v51, v51
    v_exp_f32 v52, v52
    v_cvt_pk_bf16_f32 v49, v50, v51
    v_exp_f32 v53, v53
    v_exp_f32 v54, v54
    v_cvt_pk_bf16_f32 v50, v52, v53
    v_exp_f32 v55, v55
    s_nop 0
    v_cvt_pk_bf16_f32 v51, v54, v55
    v_mfma_f32_16x16x32_bf16 v[16:19], v[12:15], v[40:43], v[16:19]
    ds_read_b128 v[76:79], v3 offset:4096
    s_waitcnt vmcnt(8)
    v_mfma_f32_16x16x32_bf16 v[192:195], v[80:83], v[48:51], v[192:195]
    ds_read_b128 v[80:83], v2 offset:2048
    v_mfma_f32_16x16x32_bf16 v[196:199], v[84:87], v[48:51], v[196:199]
    ds_read_b128 v[84:87], v3 offset:2048
    ds_inc_u32 v8, v12 offset:0
    v_mfma_f32_16x16x32_bf16 v[200:203], v[88:91], v[48:51], v[200:203]
    ds_read_b128 v[88:91], v2 offset:6144
    s_add_u32 s70, s70, 4
    v_mfma_f32_16x16x32_bf16 v[204:207], v[92:95], v[48:51], v[204:207]
    ds_read_b128 v[92:95], v3 offset:6144
    v_mfma_f32_16x16x32_bf16 v[208:211], v[96:99], v[48:51], v[208:211]
    ds_read_b32 v9, v8 offset:0
    s_add_u32 m0, s72, s76
    v_mfma_f32_16x16x32_bf16 v[212:215], v[100:103], v[48:51], v[212:215]
    buffer_load_dwordx4 v1, s[36:39], s73 offen nt lds
    s_add_u32 m0, s72, s77
    v_mfma_f32_16x16x32_bf16 v[216:219], v[104:107], v[48:51], v[216:219]
    buffer_load_dwordx4 v1, s[36:39], s73 offen offset:128 nt lds
    v_mfma_f32_16x16x32_bf16 v[220:223], v[108:111], v[48:51], v[220:223]
    s_lshr_b32 s71, s71, 1
    s_and_b32 s100, s71, 1
    s_waitcnt lgkmcnt(0)
    v_cmp_gt_u32 s[98:99], s70, v9
    v_mfma_f32_16x16x32_bf16 v[20:23], v[12:15], v[48:51], v[20:23]
    s_or_b64 s[98:99], s[98:99], s[100:101]
    s_cbranch_scc1 L_cpe_38
L_cpeb_39:
    s_nop 5
    s_branch L_A2_0
L_A2_epi:
    s_nop 7
    v_lshlrev_b32 v11, 4, v0
    v_rcp_f32 v10, v16
    s_lshl_b32 s85, s65, 11
    s_add_u32 s85, s85, s83
    v_mul_f32 v160, v160, v10
    v_mul_f32 v161, v161, v10
    v_mul_f32 v162, v162, v10
    v_mul_f32 v163, v163, v10
    v_mul_f32 v164, v164, v10
    v_mul_f32 v165, v165, v10
    v_mul_f32 v166, v166, v10
    v_mul_f32 v167, v167, v10
    v_cvt_pk_bf16_f32 v160, v160, v161
    v_cvt_pk_bf16_f32 v161, v162, v163
    v_cvt_pk_bf16_f32 v162, v164, v165
    v_cvt_pk_bf16_f32 v163, v166, v167
    buffer_store_dwordx4 v[160:163], v11, s[60:63], s85 offen sc1
    s_add_u32 s85, s85, 9216
    v_mul_f32 v168, v168, v10
    v_mul_f32 v169, v169, v10
    v_mul_f32 v170, v170, v10
    v_mul_f32 v171, v171, v10
    v_mul_f32 v172, v172, v10
    v_mul_f32 v173, v173, v10
    v_mul_f32 v174, v174, v10
    v_mul_f32 v175, v175, v10
    v_cvt_pk_bf16_f32 v168, v168, v169
    v_cvt_pk_bf16_f32 v169, v170, v171
    v_cvt_pk_bf16_f32 v170, v172, v173
    v_cvt_pk_bf16_f32 v171, v174, v175
    buffer_store_dwordx4 v[168:171], v11, s[60:63], s85 offen sc1
    s_add_u32 s85, s85, 9216
    v_mul_f32 v176, v176, v10
    v_mul_f32 v177, v177, v10
    v_mul_f32 v178, v178, v10
    v_mul_f32 v179, v179, v10
    v_mul_f32 v180, v180, v10
    v_mul_f32 v181, v181, v10
    v_mul_f32 v182, v182, v10
    v_mul_f32 v183, v183, v10
    v_cvt_pk_bf16_f32 v176, v176, v177
    v_cvt_pk_bf16_f32 v177, v178, v179
    v_cvt_pk_bf16_f32 v178, v180, v181
    v_cvt_pk_bf16_f32 v179, v182, v183
    buffer_store_dwordx4 v[176:179], v11, s[60:63], s85 offen sc1
    s_add_u32 s85, s85, 9216
    v_mul_f32 v184, v184, v10
    v_mul_f32 v185, v185, v10
    v_mul_f32 v186, v186, v10
    v_mul_f32 v187, v187, v10
    v_mul_f32 v188, v188, v10
    v_mul_f32 v189, v189, v10
    v_mul_f32 v190, v190, v10
    v_mul_f32 v191, v191, v10
    v_cvt_pk_bf16_f32 v184, v184, v185
    v_cvt_pk_bf16_f32 v185, v186, v187
    v_cvt_pk_bf16_f32 v186, v188, v189
    v_cvt_pk_bf16_f32 v187, v190, v191
    buffer_store_dwordx4 v[184:187], v11, s[60:63], s85 offen sc1
    v_rcp_f32 v10, v20
    s_lshl_b32 s85, s65, 11
    s_add_u32 s85, s85, s83
    s_add_u32 s85, s85, 1024
    v_mul_f32 v192, v192, v10
    v_mul_f32 v193, v193, v10
    v_mul_f32 v194, v194, v10
    v_mul_f32 v195, v195, v10
    v_mul_f32 v196, v196, v10
    v_mul_f32 v197, v197, v10
    v_mul_f32 v198, v198, v10
    v_mul_f32 v199, v199, v10
    v_cvt_pk_bf16_f32 v192, v192, v193
    v_cvt_pk_bf16_f32 v193, v194, v195
    v_cvt_pk_bf16_f32 v194, v196, v197
    v_cvt_pk_bf16_f32 v195, v198, v199
    buffer_store_dwordx4 v[192:195], v11, s[60:63], s85 offen sc1
    s_add_u32 s85, s85, 9216
    v_mul_f32 v200, v200, v10
    v_mul_f32 v201, v201, v10
    v_mul_f32 v202, v202, v10
    v_mul_f32 v203, v203, v10
    v_mul_f32 v204, v204, v10
    v_mul_f32 v205, v205, v10
    v_mul_f32 v206, v206, v10
    v_mul_f32 v207, v207, v10
    v_cvt_pk_bf16_f32 v200, v200, v201
    v_cvt_pk_bf16_f32 v201, v202, v203
    v_cvt_pk_bf16_f32 v202, v204, v205
    v_cvt_pk_bf16_f32 v203, v206, v207
    buffer_store_dwordx4 v[200:203], v11, s[60:63], s85 offen sc1
    s_add_u32 s85, s85, 9216
    v_mul_f32 v208, v208, v10
    v_mul_f32 v209, v209, v10
    v_mul_f32 v210, v210, v10
    v_mul_f32 v211, v211, v10
    v_mul_f32 v212, v212, v10
    v_mul_f32 v213, v213, v10
    v_mul_f32 v214, v214, v10
    v_mul_f32 v215, v215, v10
    v_cvt_pk_bf16_f32 v208, v208, v209
    v_cvt_pk_bf16_f32 v209, v210, v211
    v_cvt_pk_bf16_f32 v210, v212, v213
    v_cvt_pk_bf16_f32 v211, v214, v215
    buffer_store_dwordx4 v[208:211], v11, s[60:63], s85 offen sc1
    s_add_u32 s85, s85, 9216
    v_mul_f32 v216, v216, v10
    v_mul_f32 v217, v217, v10
    v_mul_f32 v218, v218, v10
    v_mul_f32 v219, v219, v10
    v_mul_f32 v220, v220, v10
    v_mul_f32 v221, v221, v10
    v_mul_f32 v222, v222, v10
    v_mul_f32 v223, v223, v10
    v_cvt_pk_bf16_f32 v216, v216, v217
    v_cvt_pk_bf16_f32 v217, v218, v219
    v_cvt_pk_bf16_f32 v218, v220, v221
    v_cvt_pk_bf16_f32 v219, v222, v223
    buffer_store_dwordx4 v[216:219], v11, s[60:63], s85 offen sc1
    s_add_u32 s83, s83, 36864
    s_add_u32 s81, s81, 1
    s_cmp_eq_u32 s81, 4
    s_nop 1
    s_cbranch_scc1 L_A_end
    v_mov_b32 v112, v224
    v_mov_b32 v113, v225
    v_mov_b32 v114, v226
    v_mov_b32 v115, v227
    v_mov_b32 v116, v228
    v_mov_b32 v117, v229
    v_mov_b32 v118, v230
    v_mov_b32 v119, v231
    v_mov_b32 v120, v232
    v_mov_b32 v121, v233
    v_mov_b32 v122, v234
    v_mov_b32 v123, v235
    v_mov_b32 v124, v236
    v_mov_b32 v125, v237
    v_mov_b32 v126, v238
    v_mov_b32 v127, v239
    v_mov_b32 v128, v240
    v_mov_b32 v129, v241
    v_mov_b32 v130, v242
    v_mov_b32 v131, v243
    v_mov_b32 v132, v244
    v_mov_b32 v133, v245
    v_mov_b32 v134, v246
    v_mov_b32 v135, v247
    v_mov_b32 v136, v248
    v_mov_b32 v137, v249
    v_mov_b32 v138, v250
    v_mov_b32 v139, v251
    v_mov_b32 v140, v252
    v_mov_b32 v141, v253
    v_mov_b32 v142, v254
    v_mov_b32 v143, v255
    v_mov_b32 v160, 0
    v_mov_b32 v161, 0
    v_mov_b32 v162, 0
    v_mov_b32 v163, 0
    v_mov_b32 v164, 0
    v_mov_b32 v165, 0
    v_mov_b32 v166, 0
    v_mov_b32 v167, 0
    v_mov_b32 v168, 0
    v_mov_b32 v169, 0
    v_mov_b32 v170, 0
    v_mov_b32 v171, 0
    v_mov_b32 v172, 0
    v_mov_b32 v173, 0
    v_mov_b32 v174, 0
    v_mov_b32 v175, 0
    v_mov_b32 v176, 0
    v_mov_b32 v177, 0
    v_mov_b32 v178, 0
    v_mov_b32 v179, 0
    v_mov_b32 v180, 0
    v_mov_b32 v181, 0
    v_mov_b32 v182, 0
    v_mov_b32 v183, 0
    v_mov_b32 v184, 0
    v_mov_b32 v185, 0
    v_mov_b32 v186, 0
    v_mov_b32 v187, 0
    v_mov_b32 v188, 0
    v_mov_b32 v189, 0
    v_mov_b32 v190, 0
    v_mov_b32 v191, 0
    v_mov_b32 v192, 0
    v_mov_b32 v193, 0
    v_mov_b32 v194, 0
    v_mov_b32 v195, 0
    v_mov_b32 v196, 0
    v_mov_b32 v197, 0
    v_mov_b32 v198, 0
    v_mov_b32 v199, 0
    v_mov_b32 v200, 0
    v_mov_b32 v201, 0
    v_mov_b32 v202, 0
    v_mov_b32 v203, 0
    v_mov_b32 v204, 0
    v_mov_b32 v205, 0
    v_mov_b32 v206, 0
    v_mov_b32 v207, 0
    v_mov_b32 v208, 0
    v_mov_b32 v209, 0
    v_mov_b32 v210, 0
    v_mov_b32 v211, 0
    v_mov_b32 v212, 0
    v_mov_b32 v213, 0
    v_mov_b32 v214, 0
    v_mov_b32 v215, 0
    v_mov_b32 v216, 0
    v_mov_b32 v217, 0
    v_mov_b32 v218, 0
    v_mov_b32 v219, 0
    v_mov_b32 v220, 0
    v_mov_b32 v221, 0
    v_mov_b32 v222, 0
    v_mov_b32 v223, 0
    v_mov_b32 v224, 0
    v_mov_b32 v225, 0
    v_mov_b32 v226, 0
    v_mov_b32 v227, 0
    v_mov_b32 v228, 0
    v_mov_b32 v229, 0
    v_mov_b32 v230, 0
    v_mov_b32 v231, 0
    v_mov_b32 v232, 0
    v_mov_b32 v233, 0
    v_mov_b32 v234, 0
    v_mov_b32 v235, 0
    v_mov_b32 v236, 0
    v_mov_b32 v237, 0
    v_mov_b32 v238, 0
    v_mov_b32 v239, 0
    v_mov_b32 v240, 0
    v_mov_b32 v241, 0
    v_mov_b32 v242, 0
    v_mov_b32 v243, 0
    v_mov_b32 v244, 0
    v_mov_b32 v245, 0
    v_mov_b32 v246, 0
    v_mov_b32 v247, 0
    v_mov_b32 v248, 0
    v_mov_b32 v249, 0
    v_mov_b32 v250, 0
    v_mov_b32 v251, 0
    v_mov_b32 v252, 0
    v_mov_b32 v253, 0
    v_mov_b32 v254, 0
    v_mov_b32 v255, 0
    v_mov_b32 v16, 0
    v_mov_b32 v17, 0
    v_mov_b32 v18, 0
    v_mov_b32 v19, 0
    v_mov_b32 v20, 0
    v_mov_b32 v21, 0
    v_mov_b32 v22, 0
    v_mov_b32 v23, 0
    v_mov_b32 v24, 0
    v_mov_b32 v25, 0
    v_mov_b32 v26, 0
    v_mov_b32 v27, 0
    v_mov_b32 v28, 0
    v_mov_b32 v29, 0
    v_mov_b32 v30, 0
    v_mov_b32 v31, 0
    v_mov_b32 v32, 0
    v_mov_b32 v33, 0
    v_mov_b32 v34, 0
    v_mov_b32 v35, 0
    v_mov_b32 v36, 0
    v_mov_b32 v37, 0
    v_mov_b32 v38, 0
    v_mov_b32 v39, 0
    s_mov_b32 s74, 0xff800000
    s_mov_b32 s75, 0xff800000
    s_mov_b32 s71, 65554
    s_waitcnt lgkmcnt(0)
    s_nop 1
    s_cmp_lg_u32 s81, 1
    s_cbranch_scc1 L_nx_40
    s_cmp_eq_u32 s65, 1
    s_cbranch_scc1 L_A3_1
    s_branch L_A2_1
L_nx_40:
    s_cmp_lg_u32 s81, 2
    s_cbranch_scc1 L_nx_41
    s_cmp_eq_u32 s65, 2
    s_cbranch_scc1 L_A3_2
    s_branch L_A2_2
L_nx_41:
    s_cmp_lg_u32 s81, 3
    s_cbranch_scc1 L_nx_42
    s_cmp_eq_u32 s65, 3
    s_cbranch_scc1 L_A3_0
    s_branch L_A2_0
L_nx_42:
.p2align 6
L_A3_0:
    s_waitcnt lgkmcnt(4)
    v_mfma_f32_16x16x32_bf16 v[40:43], v[64:67], v[112:115], v[28:31]
    ds_read_b64_tr_b16 v[96:97], v4 offset:8192
    s_add_u32 m0, s72, s78
    v_mfma_f32_16x16x32_bf16 v[40:43], v[68:71], v[116:119], v[40:43]
    buffer_load_dwordx4 v1, s[40:43], s73 offen nt lds
    v_mfma_f32_16x16x32_bf16 v[40:43], v[72:75], v[120:123], v[40:43]
    ds_read_b64_tr_b16 v[98:99], v4 offset:10240
    s_add_u32 m0, s72, s79
    v_mfma_f32_16x16x32_bf16 v[40:43], v[76:79], v[124:127], v[40:43]
    ds_read_b64_tr_b16 v[100:101], v5 offset:8192
    s_waitcnt lgkmcnt(5)
    v_mfma_f32_16x16x32_bf16 v[44:47], v[80:83], v[112:115], v[28:31]
    buffer_load_dwordx4 v1, s[40:43], s73 offen offset:128 nt lds
    v_mfma_f32_16x16x32_bf16 v[44:47], v[84:87], v[116:119], v[44:47]
    ds_read_b64_tr_b16 v[102:103], v5 offset:10240
    s_add_u32 s73, s73, 8192
    s_waitcnt lgkmcnt(4)
    v_mfma_f32_16x16x32_bf16 v[44:47], v[88:91], v[120:123], v[44:47]
    ds_read_b64_tr_b16 v[104:105], v6 offset:8192
    ds_read_b64_tr_b16 v[106:107], v6 offset:10240
    v_mfma_f32_16x16x32_bf16 v[44:47], v[92:95], v[124:127], v[44:47]
    ds_read_b64_tr_b16 v[108:109], v7 offset:8192
    ds_read_b64_tr_b16 v[110:111], v7 offset:10240
    v_mfma_f32_16x16x32_bf16 v[48:51], v[64:67], v[128:131], v[32:35]
    s_sub_u32 s84, s84, 1
    s_cselect_b32 s73, 1073741824, s73
    s_add_u32 s72, s72, 16384
    s_and_b32 s72, s72, 65535
    s_cmp_eq_u32 s72, 49152
    s_cselect_b32 s86, s87, 16384
    v_mfma_f32_16x16x32_bf16 v[48:51], v[68:71], v[132:135], v[48:51]
    s_waitcnt vmcnt(10)
    v_max3_f32 v10, v40, v41, v42
    v_max3_f32 v10, v10, v43, v44
    v_max3_f32 v10, v10, v45, v46
    v_max_f32 v10, v10, v47
    v_cmp_lt_f32 s[92:93], s74, v10
    v_mfma_f32_16x16x32_bf16 v[48:51], v[72:75], v[136:139], v[48:51]
    ds_inc_u32 v8, v12 offset:0
    v_mfma_f32_16x16x32_bf16 v[48:51], v[76:79], v[140:143], v[48:51]
    s_cmp_lg_u64 s[92:93], 0
    s_cbranch_scc1 L_rare_43
L_rareb_44:
    v_mfma_f32_16x16x32_bf16 v[52:55], v[80:83], v[128:131], v[32:35]
    s_add_u32 s70, s70, 4
    v_add_u32 v2, s86, v2
    v_add_u32 v3, s86, v3
    v_mfma_f32_16x16x32_bf16 v[52:55], v[84:87], v[132:135], v[52:55]
    v_exp_f32 v40, v40
    v_mfma_f32_16x16x32_bf16 v[52:55], v[88:91], v[136:139], v[52:55]
    v_exp_f32 v41, v41
    v_mfma_f32_16x16x32_bf16 v[52:55], v[92:95], v[140:143], v[52:55]
    v_exp_f32 v42, v42
    v_mfma_f32_16x16x32_bf16 v[56:59], v[64:67], v[144:147], v[36:39]
    ds_read_b64_tr_b16 v[64:65], v4 offset:12288
    v_cvt_pk_bf16_f32 v40, v40, v41
    v_mfma_f32_16x16x32_bf16 v[56:59], v[68:71], v[148:151], v[56:59]
    ds_read_b64_tr_b16 v[66:67], v4 offset:14336
    ds_read_b64_tr_b16 v[68:69], v5 offset:12288
    v_mfma_f32_16x16x32_bf16 v[56:59], v[72:75], v[152:155], v[56:59]
    ds_read_b64_tr_b16 v[70:71], v5 offset:14336
    v_exp_f32 v43, v43
    v_mfma_f32_16x16x32_bf16 v[56:59], v[76:79], v[156:159], v[56:59]
    ds_read_b64_tr_b16 v[72:73], v6 offset:12288
    v_mfma_f32_16x16x32_bf16 v[60:63], v[80:83], v[144:147], v[36:39]
    ds_read_b64_tr_b16 v[74:75], v6 offset:14336
    v_exp_f32 v44, v44
    v_mfma_f32_16x16x32_bf16 v[60:63], v[84:87], v[148:151], v[60:63]
    ds_read_b64_tr_b16 v[76:77], v7 offset:12288
    v_cvt_pk_bf16_f32 v41, v42, v43
    v_mfma_f32_16x16x32_bf16 v[60:63], v[88:91], v[152:155], v[60:63]
    ds_read_b64_tr_b16 v[78:79], v7 offset:14336
    ds_read_b32 v9, v8 offset:0
    v_exp_f32 v45, v45
    v_exp_f32 v46, v46
    v_cvt_pk_bf16_f32 v42, v44, v45
    v_exp_f32 v47, v47
    s_nop 0
    v_cvt_pk_bf16_f32 v43, v46, v47
    v_mfma_f32_16x16x32_bf16 v[60:63], v[92:95], v[156:159], v[60:63]
    v_max3_f32 v10, v48, v49, v50
    v_max3_f32 v10, v10, v51, v52
    v_max3_f32 v10, v10, v53, v54
    v_max_f32 v10, v10, v55
    v_cmp_lt_f32 s[94:95], s74, v10
    s_waitcnt lgkmcnt(10)
    v_mfma_f32_16x16x32_bf16 v[160:163], v[96:99], v[40:43], v[160:163]
    v_add_u32 v4, s86, v4
    v_add_u32 v5, s86, v5
    v_add_u32 v6, s86, v6
    v_mfma_f32_16x16x32_bf16 v[164:167], v[100:103], v[40:43], v[164:167]
    s_cmp_lg_u64 s[94:95], 0
    s_cbranch_scc1 L_rare_45
L_rareb_46:
    v_mfma_f32_16x16x32_bf16 v[168:171], v[104:107], v[40:43], v[168:171]
    s_waitcnt lgkmcnt(0)
    v_cmp_gt_u32 s[98:99], s70, v9
    v_add_u32 v7, s86, v7
    v_mfma_f32_16x16x32_bf16 v[172:175], v[108:111], v[40:43], v[172:175]
    v_max3_f32 v10, v56, v57, v58
    v_max3_f32 v10, v10, v59, v60
    v_max3_f32 v10, v10, v61, v62
    v_max_f32 v10, v10, v63
    v_cmp_lt_f32 s[96:97], s74, v10
    v_mfma_f32_16x16x32_bf16 v[176:179], v[64:67], v[40:43], v[176:179]
    v_exp_f32 v48, v48
    v_mfma_f32_16x16x32_bf16 v[180:183], v[68:71], v[40:43], v[180:183]
    s_or_b64 s[98:99], s[98:99], s[96:97]
    s_cbranch_scc1 L_rare_47
L_rareb_48:
    v_mfma_f32_16x16x32_bf16 v[184:187], v[72:75], v[40:43], v[184:187]
    v_exp_f32 v49, v49
    v_mfma_f32_16x16x32_bf16 v[188:191], v[76:79], v[40:43], v[188:191]
    s_waitcnt vmcnt(8)
    v_exp_f32 v50, v50
    v_cvt_pk_bf16_f32 v48, v48, v49
    v_exp_f32 v51, v51
    v_exp_f32 v52, v52
    v_cvt_pk_bf16_f32 v49, v50, v51
    v_exp_f32 v53, v53
    v_exp_f32 v54, v54
    v_cvt_pk_bf16_f32 v50, v52, v53
    v_exp_f32 v55, v55
    s_nop 0
    v_cvt_pk_bf16_f32 v51, v54, v55
    v_mfma_f32_16x16x32_bf16 v[16:19], v[12:15], v[40:43], v[16:19]
    ds_inc_u32 v8, v12 offset:0
    v_mfma_f32_16x16x32_bf16 v[192:195], v[96:99], v[48:51], v[192:195]
    s_add_u32 s70, s70, 4
    v_exp_f32 v56, v56
    v_mfma_f32_16x16x32_bf16 v[196:199], v[100:103], v[48:51], v[196:199]
    v_exp_f32 v57, v57
    v_mfma_f32_16x16x32_bf16 v[200:203], v[104:107], v[48:51], v[200:203]
    v_exp_f32 v58, v58
    v_cvt_pk_bf16_f32 v56, v56, v57
    v_mfma_f32_16x16x32_bf16 v[204:207], v[108:111], v[48:51], v[204:207]
    v_exp_f32 v59, v59
    v_mfma_f32_16x16x32_bf16 v[208:211], v[64:67], v[48:51], v[208:211]
    v_exp_f32 v60, v60
    v_mfma_f32_16x16x32_bf16 v[212:215], v[68:71], v[48:51], v[212:215]
    v_cvt_pk_bf16_f32 v57, v58, v59
    v_exp_f32 v61, v61
    v_mfma_f32_16x16x32_bf16 v[216:219], v[72:75], v[48:51], v[216:219]
    v_exp_f32 v62, v62
    v_mfma_f32_16x16x32_bf16 v[220:223], v[76:79], v[48:51], v[220:223]
    ds_read_b128 v[80:83], v2 offset:0
    v_cvt_pk_bf16_f32 v58, v60, v61
    v_exp_f32 v63, v63
    s_nop 0
    v_cvt_pk_bf16_f32 v59, v62, v63
    v_mfma_f32_16x16x32_bf16 v[20:23], v[12:15], v[48:51], v[20:23]
    ds_read_b128 v[84:87], v3 offset:0
    v_mfma_f32_16x16x32_bf16 v[224:227], v[96:99], v[56:59], v[224:227]
    ds_read_b128 v[88:91], v2 offset:4096
    v_mfma_f32_16x16x32_bf16 v[228:231], v[100:103], v[56:59], v[228:231]
    ds_read_b128 v[92:95], v3 offset:4096
    v_mfma_f32_16x16x32_bf16 v[232:235], v[104:107], v[56:59], v[232:235]
    ds_read_b128 v[96:99], v2 offset:2048
    s_add_u32 m0, s72, s76
    v_mfma_f32_16x16x32_bf16 v[236:239], v[108:111], v[56:59], v[236:239]
    buffer_load_dwordx4 v1, s[36:39], s73 offen nt lds
    v_mfma_f32_16x16x32_bf16 v[240:243], v[64:67], v[56:59], v[240:243]
    ds_read_b128 v[100:103], v3 offset:2048
    s_add_u32 m0, s72, s77
    v_mfma_f32_16x16x32_bf16 v[244:247], v[68:71], v[56:59], v[244:247]
    ds_read_b128 v[104:107], v2 offset:6144
    ds_read_b128 v[108:111], v3 offset:6144
    ds_read_b32 v9, v8 offset:0
    v_mfma_f32_16x16x32_bf16 v[248:251], v[72:75], v[56:59], v[248:251]
    buffer_load_dwordx4 v1, s[36:39], s73 offen offset:128 nt lds
    s_lshr_b32 s71, s71, 1
    v_mfma_f32_16x16x32_bf16 v[252:255], v[76:79], v[56:59], v[252:255]
    s_and_b32 s100, s71, 1
    s_waitcnt lgkmcnt(0)
    v_cmp_gt_u32 s[98:99], s70, v9
    v_mfma_f32_16x16x32_bf16 v[24:27], v[12:15], v[56:59], v[24:27]
    s_or_b64 s[98:99], s[98:99], s[100:101]
    s_cbranch_scc1 L_cpe_49
L_cpeb_50:
L_A3_1:
    s_waitcnt lgkmcnt(4)
    v_mfma_f32_16x16x32_bf16 v[40:43], v[80:83], v[112:115], v[28:31]
    ds_read_b64_tr_b16 v[64:65], v4 offset:8192
    s_add_u32 m0, s72, s78
    v_mfma_f32_16x16x32_bf16 v[40:43], v[84:87], v[116:119], v[40:43]
    buffer_load_dwordx4 v1, s[40:43], s73 offen nt lds
    v_mfma_f32_16x16x32_bf16 v[40:43], v[88:91], v[120:123], v[40:43]
    ds_read_b64_tr_b16 v[66:67], v4 offset:10240
    s_add_u32 m0, s72, s79
    v_mfma_f32_16x16x32_bf16 v[40:43], v[92:95], v[124:127], v[40:43]
    ds_read_b64_tr_b16 v[68:69], v5 offset:8192
    s_waitcnt lgkmcnt(5)
    v_mfma_f32_16x16x32_bf16 v[44:47], v[96:99], v[112:115], v[28:31]
    buffer_load_dwordx4 v1, s[40:43], s73 offen offset:128 nt lds
    v_mfma_f32_16x16x32_bf16 v[44:47], v[100:103], v[116:119], v[44:47]
    ds_read_b64_tr_b16 v[70:71], v5 offset:10240
    s_add_u32 s73, s73, 8192
    s_waitcnt lgkmcnt(4)
    v_mfma_f32_16x16x32_bf16 v[44:47], v[104:107], v[120:123], v[44:47]
    ds_read_b64_tr_b16 v[72:73], v6 offset:8192
    ds_read_b64_tr_b16 v[74:75], v6 offset:10240
    v_mfma_f32_16x16x32_bf16 v[44:47], v[108:111], v[124:127], v[44:47]
    ds_read_b64_tr_b16 v[76:77], v7 offset:8192
    ds_read_b64_tr_b16 v[78:79], v7 offset:10240
    v_mfma_f32_16x16x32_bf16 v[48:51], v[80:83], v[128:131], v[32:35]
    s_sub_u32 s84, s84, 1
    s_cselect_b32 s73, 1073741824, s73
    s_add_u32 s72, s72, 16384
    s_and_b32 s72, s72, 65535
    s_cmp_eq_u32 s72, 49152
    s_cselect_b32 s86, s87, 16384
    v_mfma_f32_16x16x32_bf16 v[48:51], v[84:87], v[132:135], v[48:51]
    s_waitcnt vmcnt(10)
    v_max3_f32 v10, v40, v41, v42
    v_max3_f32 v10, v10, v43, v44
    v_max3_f32 v10, v10, v45, v46
    v_max_f32 v10, v10, v47
    v_cmp_lt_f32 s[92:93], s74, v10
    v_mfma_f32_16x16x32_bf16 v[48:51], v[88:91], v[136:139], v[48:51]
    ds_inc_u32 v8, v12 offset:0
    v_mfma_f32_16x16x32_bf16 v[48:51], v[92:95], v[140:143], v[48:51]
    s_cmp_lg_u64 s[92:93], 0
    s_cbranch_scc1 L_rare_51
L_rareb_52:
    v_mfma_f32_16x16x32_bf16 v[52:55], v[96:99], v[128:131], v[32:35]
    s_add_u32 s70, s70, 4
    v_add_u32 v2, s86, v2
    v_add_u32 v3, s86, v3
    v_mfma_f32_16x16x32_bf16 v[52:55], v[100:103], v[132:135], v[52:55]
    v_exp_f32 v40, v40
    v_mfma_f32_16x16x32_bf16 v[52:55], v[104:107], v[136:139], v[52:55]
    v_exp_f32 v41, v41
    v_mfma_f32_16x16x32_bf16 v[52:55], v[108:111], v[140:143], v[52:55]
    v_exp_f32 v42, v42
    v_mfma_f32_16x16x32_bf16 v[56:59], v[80:83], v[144:147], v[36:39]
    ds_read_b64_tr_b16 v[80:81], v4 offset:12288
    v_cvt_pk_bf16_f32 v40, v40, v41
    v_mfma_f32_16x16x32_bf16 v[56:59], v[84:87], v[148:151], v[56:59]
    ds_read_b64_tr_b16 v[82:83], v4 offset:14336
    ds_read_b64_tr_b16 v[84:85], v5 offset:12288
    v_mfma_f32_16x16x32_bf16 v[56:59], v[88:91], v[152:155], v[56:59]
    ds_read_b64_tr_b16 v[86:87], v5 offset:14336
    v_exp_f32 v43, v43
    v_mfma_f32_16x16x32_bf16 v[56:59], v[92:95], v[156:159], v[56:59]
    ds_read_b64_tr_b16 v[88:89], v6 offset:12288
    v_mfma_f32_16x16x32_bf16 v[60:63], v[96:99], v[144:147], v[36:39]
    ds_read_b64_tr_b16 v[90:91], v6 offset:14336
    v_exp_f32 v44, v44
    v_mfma_f32_16x16x32_bf16 v[60:63], v[100:103], v[148:151], v[60:63]
    ds_read_b64_tr_b16 v[92:93], v7 offset:12288
    v_cvt_pk_bf16_f32 v41, v42, v43
    v_mfma_f32_16x16x32_bf16 v[60:63], v[104:107], v[152:155], v[60:63]
    ds_read_b64_tr_b16 v[94:95], v7 offset:14336
    ds_read_b32 v9, v8 offset:0
    v_exp_f32 v45, v45
    v_exp_f32 v46, v46
    v_cvt_pk_bf16_f32 v42, v44, v45
    v_exp_f32 v47, v47
    s_nop 0
    v_cvt_pk_bf16_f32 v43, v46, v47
    v_mfma_f32_16x16x32_bf16 v[60:63], v[108:111], v[156:159], v[60:63]
    v_max3_f32 v10, v48, v49, v50
    v_max3_f32 v10, v10, v51, v52
    v_max3_f32 v10, v10, v53, v54
    v_max_f32 v10, v10, v55
    v_cmp_lt_f32 s[94:95], s74, v10
    s_waitcnt lgkmcnt(10)
    v_mfma_f32_16x16x32_bf16 v[160:163], v[64:67], v[40:43], v[160:163]
    v_add_u32 v4, s86, v4
    v_add_u32 v5, s86, v5
    v_add_u32 v6, s86, v6
    v_mfma_f32_16x16x32_bf16 v[164:167], v[68:71], v[40:43], v[164:167]
    s_cmp_lg_u64 s[94:95], 0
    s_cbranch_scc1 L_rare_53
L_rareb_54:
    v_mfma_f32_16x16x32_bf16 v[168:171], v[72:75], v[40:43], v[168:171]
    s_waitcnt lgkmcnt(0)
    v_cmp_gt_u32 s[98:99], s70, v9
    v_add_u32 v7, s86, v7
    v_mfma_f32_16x16x32_bf16 v[172:175], v[76:79], v[40:43], v[172:175]
    v_max3_f32 v10, v56, v57, v58
    v_max3_f32 v10, v10, v59, v60
    v_max3_f32 v10, v10, v61, v62
    v_max_f32 v10, v10, v63
    v_cmp_lt_f32 s[96:97], s74, v10
    v_mfma_f32_16x16x32_bf16 v[176:179], v[80:83], v[40:43], v[176:179]
    v_exp_f32 v48, v48
    v_mfma_f32_16x16x32_bf16 v[180:183], v[84:87], v[40:43], v[180:183]
    s_or_b64 s[98:99], s[98:99], s[96:97]
    s_cbranch_scc1 L_rare_55
L_rareb_56:
    v_mfma_f32_16x16x32_bf16 v[184:187], v[88:91], v[40:43], v[184:187]
    v_exp_f32 v49, v49
    v_mfma_f32_16x16x32_bf16 v[188:191], v[92:95], v[40:43], v[188:191]
    s_waitcnt vmcnt(8)
    v_exp_f32 v50, v50
    v_cvt_pk_bf16_f32 v48, v48, v49
    v_exp_f32 v51, v51
    v_exp_f32 v52, v52
    v_cvt_pk_bf16_f32 v49, v50, v51
    v_exp_f32 v53, v53
    v_exp_f32 v54, v54
    v_cvt_pk_bf16_f32 v50, v52, v53
    v_exp_f32 v55, v55
    s_nop 0
    v_cvt_pk_bf16_f32 v51, v54, v55
    v_mfma_f32_16x16x32_bf16 v[16:19], v[12:15], v[40:43], v[16:19]
    ds_inc_u32 v8, v12 offset:0
    v_mfma_f32_16x16x32_bf16 v[192:195], v[64:67], v[48:51], v[192:195]
    s_add_u32 s70, s70, 4
    v_exp_f32 v56, v56
    v_mfma_f32_16x16x32_bf16 v[196:199], v[68:71], v[48:51], v[196:199]
    v_exp_f32 v57, v57
    v_mfma_f32_16x16x32_bf16 v[200:203], v[72:75], v[48:51], v[200:203]
    v_exp_f32 v58, v58
    v_cvt_pk_bf16_f32 v56, v56, v57
    v_mfma_f32_16x16x32_bf16 v[204:207], v[76:79], v[48:51], v[204:207]
    v_exp_f32 v59, v59
    v_mfma_f32_16x16x32_bf16 v[208:211], v[80:83], v[48:51], v[208:211]
    v_exp_f32 v60, v60
    v_mfma_f32_16x16x32_bf16 v[212:215], v[84:87], v[48:51], v[212:215]
    v_cvt_pk_bf16_f32 v57, v58, v59
    v_exp_f32 v61, v61
    v_mfma_f32_16x16x32_bf16 v[216:219], v[88:91], v[48:51], v[216:219]
    v_exp_f32 v62, v62
    v_mfma_f32_16x16x32_bf16 v[220:223], v[92:95], v[48:51], v[220:223]
    ds_read_b128 v[96:99], v2 offset:0
    v_cvt_pk_bf16_f32 v58, v60, v61
    v_exp_f32 v63, v63
    s_nop 0
    v_cvt_pk_bf16_f32 v59, v62, v63
    v_mfma_f32_16x16x32_bf16 v[20:23], v[12:15], v[48:51], v[20:23]
    ds_read_b128 v[100:103], v3 offset:0
    v_mfma_f32_16x16x32_bf16 v[224:227], v[64:67], v[56:59], v[224:227]
    ds_read_b128 v[104:107], v2 offset:4096
    v_mfma_f32_16x16x32_bf16 v[228:231], v[68:71], v[56:59], v[228:231]
    ds_read_b128 v[108:111], v3 offset:4096
    v_mfma_f32_16x16x32_bf16 v[232:235], v[72:75], v[56:59], v[232:235]
    ds_read_b128 v[64:67], v2 offset:2048
    s_add_u32 m0, s72, s76
    v_mfma_f32_16x16x32_bf16 v[236:239], v[76:79], v[56:59], v[236:239]
    buffer_load_dwordx4 v1, s[36:39], s73 offen nt lds
    v_mfma_f32_16x16x32_bf16 v[240:243], v[80:83], v[56:59], v[240:243]
    ds_read_b128 v[68:71], v3 offset:2048
    s_add_u32 m0, s72, s77
    v_mfma_f32_16x16x32_bf16 v[244:247], v[84:87], v[56:59], v[244:247]
    ds_read_b128 v[72:75], v2 offset:6144
    ds_read_b128 v[76:79], v3 offset:6144
    ds_read_b32 v9, v8 offset:0
    v_mfma_f32_16x16x32_bf16 v[248:251], v[88:91], v[56:59], v[248:251]
    buffer_load_dwordx4 v1, s[36:39], s73 offen offset:128 nt lds
    s_lshr_b32 s71, s71, 1
    v_mfma_f32_16x16x32_bf16 v[252:255], v[92:95], v[56:59], v[252:255]
    s_and_b32 s100, s71, 1
    s_waitcnt lgkmcnt(0)
    v_cmp_gt_u32 s[98:99], s70, v9
    v_mfma_f32_16x16x32_bf16 v[24:27], v[12:15], v[56:59], v[24:27]
    s_or_b64 s[98:99], s[98:99], s[100:101]
    s_cbranch_scc1 L_cpe_57
L_cpeb_58:
L_A3_2:
    s_waitcnt lgkmcnt(4)
    v_mfma_f32_16x16x32_bf16 v[40:43], v[96:99], v[112:115], v[28:31]
    ds_read_b64_tr_b16 v[80:81], v4 offset:8192
    s_add_u32 m0, s72, s78
    v_mfma_f32_16x16x32_bf16 v[40:43], v[100:103], v[116:119], v[40:43]
    buffer_load_dwordx4 v1, s[40:43], s73 offen nt lds
    v_mfma_f32_16x16x32_bf16 v[40:43], v[104:107], v[120:123], v[40:43]
    ds_read_b64_tr_b16 v[82:83], v4 offset:10240
    s_add_u32 m0, s72, s79
    v_mfma_f32_16x16x32_bf16 v[40:43], v[108:111], v[124:127], v[40:43]
    ds_read_b64_tr_b16 v[84:85], v5 offset:8192
    s_waitcnt lgkmcnt(5)
    v_mfma_f32_16x16x32_bf16 v[44:47], v[64:67], v[112:115], v[28:31]
    buffer_load_dwordx4 v1, s[40:43], s73 offen offset:128 nt lds
    v_mfma_f32_16x16x32_bf16 v[44:47], v[68:71], v[116:119], v[44:47]
    ds_read_b64_tr_b16 v[86:87], v5 offset:10240
    s_add_u32 s73, s73, 8192
    s_waitcnt lgkmcnt(4)
    v_mfma_f32_16x16x32_bf16 v[44:47], v[72:75], v[120:123], v[44:47]
    ds_read_b64_tr_b16 v[88:89], v6 offset:8192
    ds_read_b64_tr_b16 v[90:91], v6 offset:10240
    v_mfma_f32_16x16x32_bf16 v[44:47], v[76:79], v[124:127], v[44:47]
    ds_read_b64_tr_b16 v[92:93], v7 offset:8192
    ds_read_b64_tr_b16 v[94:95], v7 offset:10240
    v_mfma_f32_16x16x32_bf16 v[48:51], v[96:99], v[128:131], v[32:35]
    s_sub_u32 s84, s84, 1
    s_cselect_b32 s73, 1073741824, s73
    s_add_u32 s72, s72, 16384
    s_and_b32 s72, s72, 65535
    s_cmp_eq_u32 s72, 49152
    s_cselect_b32 s86, s87, 16384
    v_mfma_f32_16x16x32_bf16 v[48:51], v[100:103], v[132:135], v[48:51]
    s_waitcnt vmcnt(10)
    v_max3_f32 v10, v40, v41, v42
    v_max3_f32 v10, v10, v43, v44
    v_max3_f32 v10, v10, v45, v46
    v_max_f32 v10, v10, v47
    v_cmp_lt_f32 s[92:93], s74, v10
    v_mfma_f32_16x16x32_bf16 v[48:51], v[104:107], v[136:139], v[48:51]
    ds_inc_u32 v8, v12 offset:0
    v_mfma_f32_16x16x32_bf16 v[48:51], v[108:111], v[140:143], v[48:51]
    s_cmp_lg_u64 s[92:93], 0
    s_cbranch_scc1 L_rare_59
L_rareb_60:
    v_mfma_f32_16x16x32_bf16 v[52:55], v[64:67], v[128:131], v[32:35]
    s_add_u32 s70, s70, 4
    v_add_u32 v2, s86, v2
    v_add_u32 v3, s86, v3
    v_mfma_f32_16x16x32_bf16 v[52:55], v[68:71], v[132:135], v[52:55]
    v_exp_f32 v40, v40
    v_mfma_f32_16x16x32_bf16 v[52:55], v[72:75], v[136:139], v[52:55]
    v_exp_f32 v41, v41
    v_mfma_f32_16x16x32_bf16 v[52:55], v[76:79], v[140:143], v[52:55]
    v_exp_f32 v42, v42
    v_mfma_f32_16x16x32_bf16 v[56:59], v[96:99], v[144:147], v[36:39]
    ds_read_b64_tr_b16 v[96:97], v4 offset:12288
    v_cvt_pk_bf16_f32 v40, v40, v41
    v_mfma_f32_16x16x32_bf16 v[56:59], v[100:103], v[148:151], v[56:59]
    ds_read_b64_tr_b16 v[98:99], v4 offset:14336
    ds_read_b64_tr_b16 v[100:101], v5 offset:12288
    v_mfma_f32_16x16x32_bf16 v[56:59], v[104:107], v[152:155], v[56:59]
    ds_read_b64_tr_b16 v[102:103], v5 offset:14336
    v_exp_f32 v43, v43
    v_mfma_f32_16x16x32_bf16 v[56:59], v[108:111], v[156:159], v[56:59]
    ds_read_b64_tr_b16 v[104:105], v6 offset:12288
    v_mfma_f32_16x16x32_bf16 v[60:63], v[64:67], v[144:147], v[36:39]
    ds_read_b64_tr_b16 v[106:107], v6 offset:14336
    v_exp_f32 v44, v44
    v_mfma_f32_16x16x32_bf16 v[60:63], v[68:71], v[148:151], v[60:63]
    ds_read_b64_tr_b16 v[108:109], v7 offset:12288
    v_cvt_pk_bf16_f32 v41, v42, v43
    v_mfma_f32_16x16x32_bf16 v[60:63], v[72:75], v[152:155], v[60:63]
    ds_read_b64_tr_b16 v[110:111], v7 offset:14336
    ds_read_b32 v9, v8 offset:0
    v_exp_f32 v45, v45
    v_exp_f32 v46, v46
    v_cvt_pk_bf16_f32 v42, v44, v45
    v_exp_f32 v47, v47
    s_nop 0
    v_cvt_pk_bf16_f32 v43, v46, v47
    v_mfma_f32_16x16x32_bf16 v[60:63], v[76:79], v[156:159], v[60:63]
    v_max3_f32 v10, v48, v49, v50
    v_max3_f32 v10, v10, v51, v52
    v_max3_f32 v10, v10, v53, v54
    v_max_f32 v10, v10, v55
    v_cmp_lt_f32 s[94:95], s74, v10
    s_waitcnt lgkmcnt(10)
    v_mfma_f32_16x16x32_bf16 v[160:163], v[80:83], v[40:43], v[160:163]
    v_add_u32 v4, s86, v4
    v_add_u32 v5, s86, v5
    v_add_u32 v6, s86, v6
    v_mfma_f32_16x16x32_bf16 v[164:167], v[84:87], v[40:43], v[164:167]
    s_cmp_lg_u64 s[94:95], 0
    s_cbranch_scc1 L_rare_61
L_rareb_62:
    v_mfma_f32_16x16x32_bf16 v[168:171], v[88:91], v[40:43], v[168:171]
    s_waitcnt lgkmcnt(0)
    v_cmp_gt_u32 s[98:99], s70, v9
    v_add_u32 v7, s86, v7
    v_mfma_f32_16x16x32_bf16 v[172:175], v[92:95], v[40:43], v[172:175]
    v_max3_f32 v10, v56, v57, v58
    v_max3_f32 v10, v10, v59, v60
    v_max3_f32 v10, v10, v61, v62
    v_max_f32 v10, v10, v63
    v_cmp_lt_f32 s[96:97], s74, v10
    v_mfma_f32_16x16x32_bf16 v[176:179], v[96:99], v[40:43], v[176:179]
    v_exp_f32 v48, v48
    v_mfma_f32_16x16x32_bf16 v[180:183], v[100:103], v[40:43], v[180:183]
    s_or_b64 s[98:99], s[98:99], s[96:97]
    s_cbranch_scc1 L_rare_63
L_rareb_64:
    v_mfma_f32_16x16x32_bf16 v[184:187], v[104:107], v[40:43], v[184:187]
    v_exp_f32 v49, v49
    v_mfma_f32_16x16x32_bf16 v[188:191], v[108:111], v[40:43], v[188:191]
    s_waitcnt vmcnt(8)
    v_exp_f32 v50, v50
    v_cvt_pk_bf16_f32 v48, v48, v49
    v_exp_f32 v51, v51
    v_exp_f32 v52, v52
    v_cvt_pk_bf16_f32 v49, v50, v51
    v_exp_f32 v53, v53
    v_exp_f32 v54, v54
    v_cvt_pk_bf16_f32 v50, v52, v53
    v_exp_f32 v55, v55
    s_nop 0
    v_cvt_pk_bf16_f32 v51, v54, v55
    v_mfma_f32_16x16x32_bf16 v[16:19], v[12:15], v[40:43], v[16:19]
    ds_inc_u32 v8, v12 offset:0
    v_mfma_f32_16x16x32_bf16 v[192:195], v[80:83], v[48:51], v[192:195]
    s_add_u32 s70, s70, 4
    v_exp_f32 v56, v56
    v_mfma_f32_16x16x32_bf16 v[196:199], v[84:87], v[48:51], v[196:199]
    v_exp_f32 v57, v57
    v_mfma_f32_16x16x32_bf16 v[200:203], v[88:91], v[48:51], v[200:203]
    v_exp_f32 v58, v58
    v_cvt_pk_bf16_f32 v56, v56, v57
    v_mfma_f32_16x16x32_bf16 v[204:207], v[92:95], v[48:51], v[204:207]
    v_exp_f32 v59, v59
    v_mfma_f32_16x16x32_bf16 v[208:211], v[96:99], v[48:51], v[208:211]
    v_exp_f32 v60, v60
    v_mfma_f32_16x16x32_bf16 v[212:215], v[100:103], v[48:51], v[212:215]
    v_cvt_pk_bf16_f32 v57, v58, v59
    v_exp_f32 v61, v61
    v_mfma_f32_16x16x32_bf16 v[216:219], v[104:107], v[48:51], v[216:219]
    v_exp_f32 v62, v62
    v_mfma_f32_16x16x32_bf16 v[220:223], v[108:111], v[48:51], v[220:223]
    ds_read_b128 v[64:67], v2 offset:0
    v_cvt_pk_bf16_f32 v58, v60, v61
    v_exp_f32 v63, v63
    s_nop 0
    v_cvt_pk_bf16_f32 v59, v62, v63
    v_mfma_f32_16x16x32_bf16 v[20:23], v[12:15], v[48:51], v[20:23]
    ds_read_b128 v[68:71], v3 offset:0
    v_mfma_f32_16x16x32_bf16 v[224:227], v[80:83], v[56:59], v[224:227]
    ds_read_b128 v[72:75], v2 offset:4096
    v_mfma_f32_16x16x32_bf16 v[228:231], v[84:87], v[56:59], v[228:231]
    ds_read_b128 v[76:79], v3 offset:4096
    v_mfma_f32_16x16x32_bf16 v[232:235], v[88:91], v[56:59], v[232:235]
    ds_read_b128 v[80:83], v2 offset:2048
    s_add_u32 m0, s72, s76
    v_mfma_f32_16x16x32_bf16 v[236:239], v[92:95], v[56:59], v[236:239]
    buffer_load_dwordx4 v1, s[36:39], s73 offen nt lds
    v_mfma_f32_16x16x32_bf16 v[240:243], v[96:99], v[56:59], v[240:243]
    ds_read_b128 v[84:87], v3 offset:2048
    s_add_u32 m0, s72, s77
    v_mfma_f32_16x16x32_bf16 v[244:247], v[100:103], v[56:59], v[244:247]
    ds_read_b128 v[88:91], v2 offset:6144
    ds_read_b128 v[92:95], v3 offset:6144
    ds_read_b32 v9, v8 offset:0
    v_mfma_f32_16x16x32_bf16 v[248:251], v[104:107], v[56:59], v[248:251]
    buffer_load_dwordx4 v1, s[36:39], s73 offen offset:128 nt lds
    s_lshr_b32 s71, s71, 1
    v_mfma_f32_16x16x32_bf16 v[252:255], v[108:111], v[56:59], v[252:255]
    s_and_b32 s100, s71, 1
    s_waitcnt lgkmcnt(0)
    v_cmp_gt_u32 s[98:99], s70, v9
    v_mfma_f32_16x16x32_bf16 v[24:27], v[12:15], v[56:59], v[24:27]
    s_or_b64 s[98:99], s[98:99], s[100:101]
    s_cbranch_scc1 L_cpe_65
L_cpeb_66:
    s_nop 5
    s_branch L_A3_0
L_A3_epi:
    s_nop 7
    s_cmp_eq_u32 s81, 0
    s_mov_b32 s85, 147456
    s_cselect_b32 s85, 65536, s85
    s_cmp_eq_u32 s81, 2
    s_cselect_b32 s85, 126976, s85
    v_lshlrev_b32 v11, 4, v0
    v_add_u32 v11, s85, v11
    ds_read_b128 v[112:115], v11 offset:0
    ds_read_b128 v[116:119], v11 offset:1024
    ds_read_b128 v[120:123], v11 offset:2048
    ds_read_b128 v[124:127], v11 offset:3072
    ds_read_b128 v[128:131], v11 offset:4096
    ds_read_b128 v[132:135], v11 offset:5120
    ds_read_b128 v[136:139], v11 offset:6144
    ds_read_b128 v[140:143], v11 offset:7168
    v_lshlrev_b32 v11, 4, v0
    v_rcp_f32 v10, v16
    s_lshl_b32 s85, s65, 11
    s_add_u32 s85, s85, s83
    v_mul_f32 v160, v160, v10
    v_mul_f32 v161, v161, v10
    v_mul_f32 v162, v162, v10
    v_mul_f32 v163, v163, v10
    v_mul_f32 v164, v164, v10
    v_mul_f32 v165, v165, v10
    v_mul_f32 v166, v166, v10
    v_mul_f32 v167, v167, v10
    v_cvt_pk_bf16_f32 v160, v160, v161
    v_cvt_pk_bf16_f32 v161, v162, v163
    v_cvt_pk_bf16_f32 v162, v164, v165
    v_cvt_pk_bf16_f32 v163, v166, v167
    buffer_store_dwordx4 v[160:163], v11, s[60:63], s85 offen sc1
    s_add_u32 s85, s85, 9216
    v_mul_f32 v168, v168, v10
    v_mul_f32 v169, v169, v10
    v_mul_f32 v170, v170, v10
    v_mul_f32 v171, v171, v10
    v_mul_f32 v172, v172, v10
    v_mul_f32 v173, v173, v10
    v_mul_f32 v174, v174, v10
    v_mul_f32 v175, v175, v10
    v_cvt_pk_bf16_f32 v168, v168, v169
    v_cvt_pk_bf16_f32 v169, v170, v171
    v_cvt_pk_bf16_f32 v170, v172, v173
    v_cvt_pk_bf16_f32 v171, v174, v175
    buffer_store_dwordx4 v[168:171], v11, s[60:63], s85 offen sc1
    s_add_u32 s85, s85, 9216
    v_mul_f32 v176, v176, v10
    v_mul_f32 v177, v177, v10
    v_mul_f32 v178, v178, v10
    v_mul_f32 v179, v179, v10
    v_mul_f32 v180, v180, v10
    v_mul_f32 v181, v181, v10
    v_mul_f32 v182, v182, v10
    v_mul_f32 v183, v183, v10
    v_cvt_pk_bf16_f32 v176, v176, v177
    v_cvt_pk_bf16_f32 v177, v178, v179
    v_cvt_pk_bf16_f32 v178, v180, v181
    v_cvt_pk_bf16_f32 v179, v182, v183
    buffer_store_dwordx4 v[176:179], v11, s[60:63], s85 offen sc1
    s_add_u32 s85, s85, 9216
    v_mul_f32 v184, v184, v10
    v_mul_f32 v185, v185, v10
    v_mul_f32 v186, v186, v10
    v_mul_f32 v187, v187, v10
    v_mul_f32 v188, v188, v10
    v_mul_f32 v189, v189, v10
    v_mul_f32 v190, v190, v10
    v_mul_f32 v191, v191, v10
    v_cvt_pk_bf16_f32 v184, v184, v185
    v_cvt_pk_bf16_f32 v185, v186, v187
    v_cvt_pk_bf16_f32 v186, v188, v189
    v_cvt_pk_bf16_f32 v187, v190, v191
    buffer_store_dwordx4 v[184:187], v11, s[60:63], s85 offen sc1
    v_rcp_f32 v10, v20
    s_lshl_b32 s85, s65, 11
    s_add_u32 s85, s85, s83
    s_add_u32 s85, s85, 1024
    v_mul_f32 v192, v192, v10
    v_mul_f32 v193, v193, v10
    v_mul_f32 v194, v194, v10
    v_mul_f32 v195, v195, v10
    v_mul_f32 v196, v196, v10
    v_mul_f32 v197, v197, v10
    v_mul_f32 v198, v198, v10
    v_mul_f32 v199, v199, v10
    v_cvt_pk_bf16_f32 v192, v192, v193
    v_cvt_pk_bf16_f32 v193, v194, v195
    v_cvt_pk_bf16_f32 v194, v196, v197
    v_cvt_pk_bf16_f32 v195, v198, v199
    buffer_store_dwordx4 v[192:195], v11, s[60:63], s85 offen sc1
    s_add_u32 s85, s85, 9216
    v_mul_f32 v200, v200, v10
    v_mul_f32 v201, v201, v10
    v_mul_f32 v202, v202, v10
    v_mul_f32 v203, v203, v10
    v_mul_f32 v204, v204, v10
    v_mul_f32 v205, v205, v10
    v_mul_f32 v206, v206, v10
    v_mul_f32 v207, v207, v10
    v_cvt_pk_bf16_f32 v200, v200, v201
    v_cvt_pk_bf16_f32 v201, v202, v203
    v_cvt_pk_bf16_f32 v202, v204, v205
    v_cvt_pk_bf16_f32 v203, v206, v207
    buffer_store_dwordx4 v[200:203], v11, s[60:63], s85 offen sc1
    s_add_u32 s85, s85, 9216
    v_mul_f32 v208, v208, v10
    v_mul_f32 v209, v209, v10
    v_mul_f32 v210, v210, v10
    v_mul_f32 v211, v211, v10
    v_mul_f32 v212, v212, v10
    v_mul_f32 v213, v213, v10
    v_mul_f32 v214, v214, v10
    v_mul_f32 v215, v215, v10
    v_cvt_pk_bf16_f32 v208, v208, v209
    v_cvt_pk_bf16_f32 v209, v210, v211
    v_cvt_pk_bf16_f32 v210, v212, v213
    v_cvt_pk_bf16_f32 v211, v214, v215
    buffer_store_dwordx4 v[208:211], v11, s[60:63], s85 offen sc1
    s_add_u32 s85, s85, 9216
    v_mul_f32 v216, v216, v10
    v_mul_f32 v217, v217, v10
    v_mul_f32 v218, v218, v10
    v_mul_f32 v219, v219, v10
    v_mul_f32 v220, v220, v10
    v_mul_f32 v221, v221, v10
    v_mul_f32 v222, v222, v10
    v_mul_f32 v223, v223, v10
    v_cvt_pk_bf16_f32 v216, v216, v217
    v_cvt_pk_bf16_f32 v217, v218, v219
    v_cvt_pk_bf16_f32 v218, v220, v221
    v_cvt_pk_bf16_f32 v219, v222, v223
    buffer_store_dwordx4 v[216:219], v11, s[60:63], s85 offen sc1
    v_rcp_f32 v10, v24
    s_add_u32 s85, s83, 8192
    v_mul_f32 v224, v224, v10
    v_mul_f32 v225, v225, v10
    v_mul_f32 v226, v226, v10
    v_mul_f32 v227, v227, v10
    v_mul_f32 v228, v228, v10
    v_mul_f32 v229, v229, v10
    v_mul_f32 v230, v230, v10
    v_mul_f32 v231, v231, v10
    v_cvt_pk_bf16_f32 v224, v224, v225
    v_cvt_pk_bf16_f32 v225, v226, v227
    v_cvt_pk_bf16_f32 v226, v228, v229
    v_cvt_pk_bf16_f32 v227, v230, v231
    buffer_store_dwordx4 v[224:227], v11, s[60:63], s85 offen sc1
    s_add_u32 s85, s85, 9216
    v_mul_f32 v232, v232, v10
    v_mul_f32 v233, v233, v10
    v_mul_f32 v234, v234, v10
    v_mul_f32 v235, v235, v10
    v_mul_f32 v236, v236, v10
    v_mul_f32 v237, v237, v10
    v_mul_f32 v238, v238, v10
    v_mul_f32 v239, v239, v10
    v_cvt_pk_bf16_f32 v232, v232, v233
    v_cvt_pk_bf16_f32 v233, v234, v235
    v_cvt_pk_bf16_f32 v234, v236, v237
    v_cvt_pk_bf16_f32 v235, v238, v239
    buffer_store_dwordx4 v[232:235], v11, s[60:63], s85 offen sc1
    s_add_u32 s85, s85, 9216
    v_mul_f32 v240, v240, v10
    v_mul_f32 v241, v241, v10
    v_mul_f32 v242, v242, v10
    v_mul_f32 v243, v243, v10
    v_mul_f32 v244, v244, v10
    v_mul_f32 v245, v245, v10
    v_mul_f32 v246, v246, v10
    v_mul_f32 v247, v247, v10
    v_cvt_pk_bf16_f32 v240, v240, v241
    v_cvt_pk_bf16_f32 v241, v242, v243
    v_cvt_pk_bf16_f32 v242, v244, v245
    v_cvt_pk_bf16_f32 v243, v246, v247
    buffer_store_dwordx4 v[240:243], v11, s[60:63], s85 offen sc1
    s_add_u32 s85, s85, 9216
    v_mul_f32 v248, v248, v10
    v_mul_f32 v249, v249, v10
    v_mul_f32 v250, v250, v10
    v_mul_f32 v251, v251, v10
    v_mul_f32 v252, v252, v10
    v_mul_f32 v253, v253, v10
    v_mul_f32 v254, v254, v10
    v_mul_f32 v255, v255, v10
    v_cvt_pk_bf16_f32 v248, v248, v249
    v_cvt_pk_bf16_f32 v249, v250, v251
    v_cvt_pk_bf16_f32 v250, v252, v253
    v_cvt_pk_bf16_f32 v251, v254, v255
    buffer_store_dwordx4 v[248:251], v11, s[60:63], s85 offen sc1
    s_add_u32 s83, s83, 36864
    s_add_u32 s81, s81, 1
    s_cmp_eq_u32 s81, 4
    s_nop 1
    s_cbranch_scc1 L_A_end
    v_mov_b32 v160, 0
    v_mov_b32 v161, 0
    v_mov_b32 v162, 0
    v_mov_b32 v163, 0
    v_mov_b32 v164, 0
    v_mov_b32 v165, 0
    v_mov_b32 v166, 0
    v_mov_b32 v167, 0
    v_mov_b32 v168, 0
    v_mov_b32 v169, 0
    v_mov_b32 v170, 0
    v_mov_b32 v171, 0
    v_mov_b32 v172, 0
    v_mov_b32 v173, 0
    v_mov_b32 v174, 0
    v_mov_b32 v175, 0
    v_mov_b32 v176, 0
    v_mov_b32 v177, 0
    v_mov_b32 v178, 0
    v_mov_b32 v179, 0
    v_mov_b32 v180, 0
    v_mov_b32 v181, 0
    v_mov_b32 v182, 0
    v_mov_b32 v183, 0
    v_mov_b32 v184, 0
    v_mov_b32 v185, 0
    v_mov_b32 v186, 0
    v_mov_b32 v187, 0
    v_mov_b32 v188, 0
    v_mov_b32 v189, 0
    v_mov_b32 v190, 0
    v_mov_b32 v191, 0
    v_mov_b32 v192, 0
    v_mov_b32 v193, 0
    v_mov_b32 v194, 0
    v_mov_b32 v195, 0
    v_mov_b32 v196, 0
    v_mov_b32 v197, 0
    v_mov_b32 v198, 0
    v_mov_b32 v199, 0
    v_mov_b32 v200, 0
    v_mov_b32 v201, 0
    v_mov_b32 v202, 0
    v_mov_b32 v203, 0
    v_mov_b32 v204, 0
    v_mov_b32 v205, 0
    v_mov_b32 v206, 0
    v_mov_b32 v207, 0
    v_mov_b32 v208, 0
    v_mov_b32 v209, 0
    v_mov_b32 v210, 0
    v_mov_b32 v211, 0
    v_mov_b32 v212, 0
    v_mov_b32 v213, 0
    v_mov_b32 v214, 0
    v_mov_b32 v215, 0
    v_mov_b32 v216, 0
    v_mov_b32 v217, 0
    v_mov_b32 v218, 0
    v_mov_b32 v219, 0
    v_mov_b32 v220, 0
    v_mov_b32 v221, 0
    v_mov_b32 v222, 0
    v_mov_b32 v223, 0
    v_mov_b32 v224, 0
    v_mov_b32 v225, 0
    v_mov_b32 v226, 0
    v_mov_b32 v227, 0
    v_mov_b32 v228, 0
    v_mov_b32 v229, 0
    v_mov_b32 v230, 0
    v_mov_b32 v231, 0
    v_mov_b32 v232, 0
    v_mov_b32 v233, 0
    v_mov_b32 v234, 0
    v_mov_b32 v235, 0
    v_mov_b32 v236, 0
    v_mov_b32 v237, 0
    v_mov_b32 v238, 0
    v_mov_b32 v239, 0
    v_mov_b32 v240, 0
    v_mov_b32 v241, 0
    v_mov_b32 v242, 0
    v_mov_b32 v243, 0
    v_mov_b32 v244, 0
    v_mov_b32 v245, 0
    v_mov_b32 v246, 0
    v_mov_b32 v247, 0
    v_mov_b32 v248, 0
    v_mov_b32 v249, 0
    v_mov_b32 v250, 0
    v_mov_b32 v251, 0
    v_mov_b32 v252, 0
    v_mov_b32 v253, 0
    v_mov_b32 v254, 0
    v_mov_b32 v255, 0
    v_mov_b32 v16, 0
    v_mov_b32 v17, 0
    v_mov_b32 v18, 0
    v_mov_b32 v19, 0
    v_mov_b32 v20, 0
    v_mov_b32 v21, 0
    v_mov_b32 v22, 0
    v_mov_b32 v23, 0
    v_mov_b32 v24, 0
    v_mov_b32 v25, 0
    v_mov_b32 v26, 0
    v_mov_b32 v27, 0
    v_mov_b32 v28, 0
    v_mov_b32 v29, 0
    v_mov_b32 v30, 0
    v_mov_b32 v31, 0
    v_mov_b32 v32, 0
    v_mov_b32 v33, 0
    v_mov_b32 v34, 0
    v_mov_b32 v35, 0
    v_mov_b32 v36, 0
    v_mov_b32 v37, 0
    v_mov_b32 v38, 0
    v_mov_b32 v39, 0
    s_mov_b32 s74, 0xff800000
    s_mov_b32 s75, 0xff800000
    s_mov_b32 s71, 65554
    s_waitcnt lgkmcnt(0)
    s_nop 1
    s_cmp_eq_u32 s81, 1
    s_cbranch_scc1 L_A2_1
    s_cmp_eq_u32 s81, 2
    s_cbranch_scc1 L_A2_2
    s_branch L_A2_0
L_A_end:
    s_waitcnt vmcnt(0) lgkmcnt(0)
    s_add_u32 s70, s70, 4
    ds_inc_u32 v8, v12 offset:0
    s_cmp_lg_u32 s65, 0
    s_cbranch_scc1 L_bail
L_fw_67:
    s_sub_u32 s90, s90, 1
    s_cbranch_scc1 L_bail
    ds_read_b32 v9, v8 offset:0
    s_waitcnt lgkmcnt(0)
    v_cmp_gt_u32 vcc, s70, v9
    s_cbranch_vccnz L_fw_67
    s_lshl_b32 s85, s66, 3
    s_add_u32 s85, s85, s68
    s_lshl_b32 s85, s85, 8
    s_add_u32 s85, s85, 40000000
    v_mov_b32 v10, s85
    v_mov_b32 v9, s81
    s_mov_b64 exec, 1
    buffer_store_dword v9, v10, s[60:63], 0 offen sc1
    s_mov_b64 exec, -1
    ds_inc_u32 v8, v12 offset:1024
    s_nop 1
    s_branch L_bail
L_rare_22:
    s_call_b64 s[88:89], L_rare0
    s_branch L_rareb_23
L_rare_24:
L_fw_68:
    s_sub_u32 s90, s90, 1
    s_cbranch_scc1 L_bail
    ds_read_b32 v9, v8 offset:0
    s_waitcnt lgkmcnt(0)
    v_cmp_gt_u32 vcc, s70, v9
    s_cbranch_vccnz L_fw_68
    s_cmp_eq_u64 s[94:95], 0
    s_cbranch_scc1 L_rareb_25
    s_call_b64 s[88:89], L_rare1
    s_branch L_rareb_25
L_cpe_26:
    s_nop 7
L_fw_69:
    s_sub_u32 s90, s90, 1
    s_cbranch_scc1 L_bail
    ds_read_b32 v9, v8 offset:0
    s_waitcnt lgkmcnt(0)
    v_cmp_gt_u32 vcc, s70, v9
    s_cbranch_vccnz L_fw_69
    s_cmp_eq_u32 s100, 0
    s_cbranch_scc1 L_cpeb_27
    s_cmp_eq_u32 s71, 1
    s_cbranch_scc1 L_A2_epi
    s_mov_b32 s74, 0x41800000
    s_mov_b32 s75, 0
    s_cmp_lg_u32 s71, 4097
    s_cbranch_scc1 L_cpeb_27
    s_call_b64 s[88:89], L_qwork2
    s_branch L_cpeb_27
L_rare_28:
    s_call_b64 s[88:89], L_rare0
    s_branch L_rareb_29
L_rare_30:
L_fw_70:
    s_sub_u32 s90, s90, 1
    s_cbranch_scc1 L_bail
    ds_read_b32 v9, v8 offset:0
    s_waitcnt lgkmcnt(0)
    v_cmp_gt_u32 vcc, s70, v9
    s_cbranch_vccnz L_fw_70
    s_cmp_eq_u64 s[94:95], 0
    s_cbranch_scc1 L_rareb_31
    s_call_b64 s[88:89], L_rare1
    s_branch L_rareb_31
L_cpe_32:
    s_nop 7
L_fw_71:
    s_sub_u32 s90, s90, 1
    s_cbranch_scc1 L_bail
    ds_read_b32 v9, v8 offset:0
    s_waitcnt lgkmcnt(0)
    v_cmp_gt_u32 vcc, s70, v9
    s_cbranch_vccnz L_fw_71
    s_cmp_eq_u32 s100, 0
    s_cbranch_scc1 L_cpeb_33
    s_cmp_eq_u32 s71, 1
    s_cbranch_scc1 L_A2_epi
    s_mov_b32 s74, 0x41800000
    s_mov_b32 s75, 0
    s_cmp_lg_u32 s71, 4097
    s_cbranch_scc1 L_cpeb_33
    s_call_b64 s[88:89], L_qwork2
    s_branch L_cpeb_33
L_rare_34:
    s_call_b64 s[88:89], L_rare0
    s_branch L_rareb_35
L_rare_36:
L_fw_72:
    s_sub_u32 s90, s90, 1
    s_cbranch_scc1 L_bail
    ds_read_b32 v9, v8 offset:0
    s_waitcnt lgkmcnt(0)
    v_cmp_gt_u32 vcc, s70, v9
    s_cbranch_vccnz L_fw_72
    s_cmp_eq_u64 s[94:95], 0
    s_cbranch_scc1 L_rareb_37
    s_call_b64 s[88:89], L_rare1
    s_branch L_rareb_37
L_cpe_38:
    s_nop 7
L_fw_73:
    s_sub_u32 s90, s90, 1
    s_cbranch_scc1 L_bail
    ds_read_b32 v9, v8 offset:0
    s_waitcnt lgkmcnt(0)
    v_cmp_gt_u32 vcc, s70, v9
    s_cbranch_vccnz L_fw_73
    s_cmp_eq_u32 s100, 0
    s_cbranch_scc1 L_cpeb_39
    s_cmp_eq_u32 s71, 1
    s_cbranch_scc1 L_A2_epi
    s_mov_b32 s74, 0x41800000
    s_mov_b32 s75, 0
    s_cmp_lg_u32 s71, 4097
    s_cbranch_scc1 L_cpeb_39
    s_call_b64 s[88:89], L_qwork2
    s_branch L_cpeb_39
L_rare_43:
    s_call_b64 s[88:89], L_rare0
    s_branch L_rareb_44
L_rare_45:
    s_call_b64 s[88:89], L_rare1
    s_branch L_rareb_46
L_rare_47:
L_fw_74:
    s_sub_u32 s90, s90, 1
    s_cbranch_scc1 L_bail
    ds_read_b32 v9, v8 offset:0
    s_waitcnt lgkmcnt(0)
    v_cmp_gt_u32 vcc, s70, v9
    s_cbranch_vccnz L_fw_74
    s_cmp_eq_u64 s[96:97], 0
    s_cbranch_scc1 L_rareb_48
    s_call_b64 s[88:89], L_rare2
    s_branch L_rareb_48
L_cpe_49:
    s_nop 7
L_fw_75:
    s_sub_u32 s90, s90, 1
    s_cbranch_scc1 L_bail
    ds_read_b32 v9, v8 offset:0
    s_waitcnt lgkmcnt(0)
    v_cmp_gt_u32 vcc, s70, v9
    s_cbranch_vccnz L_fw_75
    s_cmp_eq_u32 s100, 0
    s_cbranch_scc1 L_cpeb_50
    s_cmp_eq_u32 s71, 1
    s_cbranch_scc1 L_A3_epi
    s_mov_b32 s74, 0x41800000
    s_mov_b32 s75, 0
    s_cmp_lg_u32 s71, 4097
    s_cbranch_scc1 L_cpeb_50
    s_call_b64 s[88:89], L_qwork3
    s_branch L_cpeb_50
L_rare_51:
    s_call_b64 s[88:89], L_rare0
    s_branch L_rareb_52
L_rare_53:
    s_call_b64 s[88:89], L_rare1
    s_branch L_rareb_54
L_rare_55:
L_fw_76:
    s_sub_u32 s90, s90, 1
    s_cbranch_scc1 L_bail
    ds_read_b32 v9, v8 offset:0
    s_waitcnt lgkmcnt(0)
    v_cmp_gt_u32 vcc, s70, v9
    s_cbranch_vccnz L_fw_76
    s_cmp_eq_u64 s[96:97], 0
    s_cbranch_scc1 L_rareb_56
    s_call_b64 s[88:89], L_rare2
    s_branch L_rareb_56
L_cpe_57:
    s_nop 7
L_fw_77:
    s_sub_u32 s90, s90, 1
    s_cbranch_scc1 L_bail
    ds_read_b32 v9, v8 offset:0
    s_waitcnt lgkmcnt(0)
    v_cmp_gt_u32 vcc, s70, v9
    s_cbranch_vccnz L_fw_77
    s_cmp_eq_u32 s100, 0
    s_cbranch_scc1 L_cpeb_58
    s_cmp_eq_u32 s71, 1
    s_cbranch_scc1 L_A3_epi
    s_mov_b32 s74, 0x41800000
    s_mov_b32 s75, 0
    s_cmp_lg_u32 s71, 4097
    s_cbranch_scc1 L_cpeb_58
    s_call_b64 s[88:89], L_qwork3
    s_branch L_cpeb_58
L_rare_59:
    s_call_b64 s[88:89], L_rare0
    s_branch L_rareb_60
L_rare_61:
    s_call_b64 s[88:89], L_rare1
    s_branch L_rareb_62
L_rare_63:
L_fw_78:
    s_sub_u32 s90, s90, 1
    s_cbranch_scc1 L_bail
    ds_read_b32 v9, v8 offset:0
    s_waitcnt lgkmcnt(0)
    v_cmp_gt_u32 vcc, s70, v9
    s_cbranch_vccnz L_fw_78
    s_cmp_eq_u64 s[96:97], 0
    s_cbranch_scc1 L_rareb_64
    s_call_b64 s[88:89], L_rare2
    s_branch L_rareb_64
L_cpe_65:
    s_nop 7
L_fw_79:
    s_sub_u32 s90, s90, 1
    s_cbranch_scc1 L_bail
    ds_read_b32 v9, v8 offset:0
    s_waitcnt lgkmcnt(0)
    v_cmp_gt_u32 vcc, s70, v9
    s_cbranch_vccnz L_fw_79
    s_cmp_eq_u32 s100, 0
    s_cbranch_scc1 L_cpeb_66
    s_cmp_eq_u32 s71, 1
    s_cbranch_scc1 L_A3_epi
    s_mov_b32 s74, 0x41800000
    s_mov_b32 s75, 0
    s_cmp_lg_u32 s71, 4097
    s_cbranch_scc1 L_cpeb_66
    s_call_b64 s[88:89], L_qwork3
    s_branch L_cpeb_66
L_rare0:
    s_nop 7
    s_waitcnt lgkmcnt(0)
    v_max3_f32 v10, v40, v41, v42
    v_max3_f32 v10, v10, v43, v44
    v_max3_f32 v10, v10, v45, v46
    v_max_f32 v10, v10, v47
    v_mov_b32 v9, v10
    s_nop 1
    v_permlane32_swap_b32 v10, v9
    v_max_f32 v10, v10, v9
    v_mov_b32 v9, v10
    s_nop 1
    v_permlane16_swap_b32 v10, v9
    v_max_f32 v10, v10, v9
    v_max_f32 v10, s75, v10
    v_sub_f32 v40, v40, v10
    v_sub_f32 v41, v41, v10
    v_sub_f32 v42, v42, v10
    v_sub_f32 v43, v43, v10
    v_sub_f32 v44, v44, v10
    v_sub_f32 v45, v45, v10
    v_sub_f32 v46, v46, v10
    v_sub_f32 v47, v47, v10
    v_sub_f32 v28, v28, v10
    v_sub_f32 v29, v29, v10
    v_sub_f32 v30, v30, v10
    v_sub_f32 v31, v31, v10
    s_cmp_lg_u32 s75, 0
    s_cbranch_scc1 L_rfirst_80
    v_exp_f32 v9, -v10
    s_nop 0
    v_mul_f32 v16, v16, v9
    v_mul_f32 v17, v17, v9
    v_mul_f32 v18, v18, v9
    v_mul_f32 v19, v19, v9
    v_mul_f32 v160, v160, v9
    v_mul_f32 v161, v161, v9
    v_mul_f32 v162, v162, v9
    v_mul_f32 v163, v163, v9
    v_mul_f32 v164, v164, v9
    v_mul_f32 v165, v165, v9
    v_mul_f32 v166, v166, v9
    v_mul_f32 v167, v167, v9
    v_mul_f32 v168, v168, v9
    v_mul_f32 v169, v169, v9
    v_mul_f32 v170, v170, v9
    v_mul_f32 v171, v171, v9
    v_mul_f32 v172, v172, v9
    v_mul_f32 v173, v173, v9
    v_mul_f32 v174, v174, v9
    v_mul_f32 v175, v175, v9
    v_mul_f32 v176, v176, v9
    v_mul_f32 v177, v177, v9
    v_mul_f32 v178, v178, v9
    v_mul_f32 v179, v179, v9
    v_mul_f32 v180, v180, v9
    v_mul_f32 v181, v181, v9
    v_mul_f32 v182, v182, v9
    v_mul_f32 v183, v183, v9
    v_mul_f32 v184, v184, v9
    v_mul_f32 v185, v185, v9
    v_mul_f32 v186, v186, v9
    v_mul_f32 v187, v187, v9
    v_mul_f32 v188, v188, v9
    v_mul_f32 v189, v189, v9
    v_mul_f32 v190, v190, v9
    v_mul_f32 v191, v191, v9
L_rfirst_80:
    ds_read_b32 v9, v8 offset:0
    s_waitcnt lgkmcnt(0)
    s_nop 1
    s_nop 1
    s_setpc_b64 s[88:89]
L_rare1:
    s_nop 7
    s_waitcnt lgkmcnt(0)
    v_max3_f32 v10, v48, v49, v50
    v_max3_f32 v10, v10, v51, v52
    v_max3_f32 v10, v10, v53, v54
    v_max_f32 v10, v10, v55
    v_mov_b32 v9, v10
    s_nop 1
    v_permlane32_swap_b32 v10, v9
    v_max_f32 v10, v10, v9
    v_mov_b32 v9, v10
    s_nop 1
    v_permlane16_swap_b32 v10, v9
    v_max_f32 v10, v10, v9
    v_max_f32 v10, s75, v10
    v_sub_f32 v48, v48, v10
    v_sub_f32 v49, v49, v10
    v_sub_f32 v50, v50, v10
    v_sub_f32 v51, v51, v10
    v_sub_f32 v52, v52, v10
    v_sub_f32 v53, v53, v10
    v_sub_f32 v54, v54, v10
    v_sub_f32 v55, v55, v10
    v_sub_f32 v32, v32, v10
    v_sub_f32 v33, v33, v10
    v_sub_f32 v34, v34, v10
    v_sub_f32 v35, v35, v10
    s_cmp_lg_u32 s75, 0
    s_cbranch_scc1 L_rfirst_81
    v_exp_f32 v9, -v10
    s_nop 0
    v_mul_f32 v20, v20, v9
    v_mul_f32 v21, v21, v9
    v_mul_f32 v22, v22, v9
    v_mul_f32 v23, v23, v9
    v_mul_f32 v192, v192, v9
    v_mul_f32 v193, v193, v9
    v_mul_f32 v194, v194, v9
    v_mul_f32 v195, v195, v9
    v_mul_f32 v196, v196, v9
    v_mul_f32 v197, v197, v9
    v_mul_f32 v198, v198, v9
    v_mul_f32 v199, v199, v9
    v_mul_f32 v200, v200, v9
    v_mul_f32 v201, v201, v9
    v_mul_f32 v202, v202, v9
    v_mul_f32 v203, v203, v9
    v_mul_f32 v204, v204, v9
    v_mul_f32 v205, v205, v9
    v_mul_f32 v206, v206, v9
    v_mul_f32 v207, v207, v9
    v_mul_f32 v208, v208, v9
    v_mul_f32 v209, v209, v9
    v_mul_f32 v210, v210, v9
    v_mul_f32 v211, v211, v9
    v_mul_f32 v212, v212, v9
    v_mul_f32 v213, v213, v9
    v_mul_f32 v214, v214, v9
    v_mul_f32 v215, v215, v9
    v_mul_f32 v216, v216, v9
    v_mul_f32 v217, v217, v9
    v_mul_f32 v218, v218, v9
    v_mul_f32 v219, v219, v9
    v_mul_f32 v220, v220, v9
    v_mul_f32 v221, v221, v9
    v_mul_f32 v222, v222, v9
    v_mul_f32 v223, v223, v9
L_rfirst_81:
    ds_read_b32 v9, v8 offset:0
    s_waitcnt lgkmcnt(0)
    s_nop 1
    s_nop 1
    s_setpc_b64 s[88:89]
L_rare2:
    s_nop 7
    s_waitcnt lgkmcnt(0)
    v_max3_f32 v10, v56, v57, v58
    v_max3_f32 v10, v10, v59, v60
    v_max3_f32 v10, v10, v61, v62
    v_max_f32 v10, v10, v63
    v_mov_b32 v9, v10
    s_nop 1
    v_permlane32_swap_b32 v10, v9
    v_max_f32 v10, v10, v9
    v_mov_b32 v9, v10
    s_nop 1
    v_permlane16_swap_b32 v10, v9
    v_max_f32 v10, v10, v9
    v_max_f32 v10, s75, v10
    v_sub_f32 v56, v56, v10
    v_sub_f32 v57, v57, v10
    v_sub_f32 v58, v58, v10
    v_sub_f32 v59, v59, v10
    v_sub_f32 v60, v60, v10
    v_sub_f32 v61, v61, v10
    v_sub_f32 v62, v62, v10
    v_sub_f32 v63, v63, v10
    v_sub_f32 v36, v36, v10
    v_sub_f32 v37, v37, v10
    v_sub_f32 v38, v38, v10
    v_sub_f32 v39, v39, v10
    s_cmp_lg_u32 s75, 0
    s_cbranch_scc1 L_rfirst_82
    v_exp_f32 v9, -v10
    s_nop 0
    v_mul_f32 v24, v24, v9
    v_mul_f32 v25, v25, v9
    v_mul_f32 v26, v26, v9
    v_mul_f32 v27, v27, v9
    v_mul_f32 v224, v224, v9
    v_mul_f32 v225, v225, v9
    v_mul_f32 v226, v226, v9
    v_mul_f32 v227, v227, v9
    v_mul_f32 v228, v228, v9
    v_mul_f32 v229, v229, v9
    v_mul_f32 v230, v230, v9
    v_mul_f32 v231, v231, v9
    v_mul_f32 v232, v232, v9
    v_mul_f32 v233, v233, v9
    v_mul_f32 v234, v234, v9
    v_mul_f32 v235, v235, v9
    v_mul_f32 v236, v236, v9
    v_mul_f32 v237, v237, v9
    v_mul_f32 v238, v238, v9
    v_mul_f32 v239, v239, v9
    v_mul_f32 v240, v240, v9
    v_mul_f32 v241, v241, v9
    v_mul_f32 v242, v242, v9
    v_mul_f32 v243, v243, v9
    v_mul_f32 v244, v244, v9
    v_mul_f32 v245, v245, v9
    v_mul_f32 v246, v246, v9
    v_mul_f32 v247, v247, v9
    v_mul_f32 v248, v248, v9
    v_mul_f32 v249, v249, v9
    v_mul_f32 v250, v250, v9
    v_mul_f32 v251, v251, v9
    v_mul_f32 v252, v252, v9
    v_mul_f32 v253, v253, v9
    v_mul_f32 v254, v254, v9
    v_mul_f32 v255, v255, v9
L_rfirst_82:
    ds_read_b32 v9, v8 offset:0
    s_waitcnt lgkmcnt(0)
    s_nop 1
    s_nop 1
    s_setpc_b64 s[88:89]
L_qwork2:
    s_nop 7
    s_cmp_eq_u32 s81, 0
    s_cbranch_scc1 L_qskip_83
    s_cmp_lg_u32 s65, 0
    s_cbranch_scc1 L_nosig_84
    s_lshl_b32 s85, s66, 3
    s_add_u32 s85, s85, s68
    s_lshl_b32 s85, s85, 8
    s_add_u32 s85, s85, 40000000
    v_mov_b32 v10, s85
    v_mov_b32 v9, s81
    s_mov_b64 exec, 1
    buffer_store_dword v9, v10, s[60:63], 0 offen sc1
    s_mov_b64 exec, -1
    ds_inc_u32 v8, v12 offset:1024
L_nosig_84:
    s_cmp_eq_u32 s81, 3
    s_cbranch_scc1 L_qskip_83
    s_mov_b32 s85, 8
L_fw_85:
    s_sub_u32 s90, s90, 1
    s_cbranch_scc1 L_bail
    ds_read_b32 v9, v8 offset:512
    s_waitcnt lgkmcnt(0)
    v_cmp_gt_u32 vcc, s85, v9
    s_cbranch_vccnz L_fw_85
    s_cmp_eq_u32 s81, 1
    s_mov_b32 s85, 110592
    s_cselect_b32 s85, 73728, s85
    v_lshlrev_b32 v11, 4, v0
    v_add_u32 v11, s85, v11
    ds_read_b128 v[144:147], v11 offset:32768
    ds_read_b128 v[148:151], v11 offset:33792
    ds_read_b128 v[152:155], v11 offset:34816
    ds_read_b128 v[156:159], v11 offset:35840
    s_lshl_b32 s82, s65, 13
    v_add_u32 v11, s82, v11
    ds_read_b128 v[224:227], v11 offset:0
    ds_read_b128 v[228:231], v11 offset:1024
    ds_read_b128 v[232:235], v11 offset:2048
    ds_read_b128 v[236:239], v11 offset:3072
    ds_read_b128 v[240:243], v11 offset:4096
    ds_read_b128 v[244:247], v11 offset:5120
    ds_read_b128 v[248:251], v11 offset:6144
    ds_read_b128 v[252:255], v11 offset:7168
    s_waitcnt lgkmcnt(0)
    ds_inc_u32 v8, v12 offset:768
L_qskip_83:
    s_nop 1
    s_setpc_b64 s[88:89]
L_qwork3:
    s_nop 7
    s_cmp_eq_u32 s81, 0
    s_cbranch_scc1 L_qskip_86
    s_cmp_lg_u32 s65, 0
    s_cbranch_scc1 L_nosig_87
    s_lshl_b32 s85, s66, 3
    s_add_u32 s85, s85, s68
    s_lshl_b32 s85, s85, 8
    s_add_u32 s85, s85, 40000000
    v_mov_b32 v10, s85
    v_mov_b32 v9, s81
    s_mov_b64 exec, 1
    buffer_store_dword v9, v10, s[60:63], 0 offen sc1
    s_mov_b64 exec, -1
    ds_inc_u32 v8, v12 offset:1024
L_nosig_87:
    s_cmp_eq_u32 s81, 3
    s_cbranch_scc1 L_qskip_86
    s_mov_b32 s85, 8
L_fw_88:
    s_sub_u32 s90, s90, 1
    s_cbranch_scc1 L_bail
    ds_read_b32 v9, v8 offset:512
    s_waitcnt lgkmcnt(0)
    v_cmp_gt_u32 vcc, s85, v9
    s_cbranch_vccnz L_fw_88
    ds_inc_u32 v8, v12 offset:768
L_qskip_86:
    s_nop 2
    s_setpc_b64 s[88:89]
L_bail:
    s_waitcnt vmcnt(0) lgkmcnt(0)
L_end:
    s_endpgm
.section .rodata,"a"
.p2align 6
.amdhsa_kernel concat_heads__mha_block_cached__gqa_block_cached__near_ridge_kernel
  .amdhsa_next_free_vgpr 256
  .amdhsa_next_free_sgpr 102
  .amdhsa_accum_offset 256
  .amdhsa_group_segment_fixed_size 0
  .amdhsa_kernarg_size 104
  .amdhsa_user_sgpr_count 2
  .amdhsa_user_sgpr_kernarg_segment_ptr 1
  .amdhsa_system_sgpr_workgroup_id_x 1
.end_amdhsa_kernel
```
